```python
import torch

def _softmax(x, axis=-1):
    return torch.softmax(x, dim=axis)
def _gelu(x):
    return torch.nn.functional.gelu(x, approximate="tanh")
def _silu(x):
    return torch.nn.functional.silu(x)
def _sigmoid(x):
    return torch.sigmoid(x)
def _layernorm(x, axis=-1, eps=1e-5):
    m = x.mean(dim=axis, keepdim=True)
    v = x.var(dim=axis, keepdim=True, unbiased=False)
    return (x - m) / torch.sqrt(v + eps)
def _scatter_add(tgt, idx, src, axis=0):
    return tgt.clone().index_add_(axis, idx, src)
def _segment_sum(src, seg, n):
    out = torch.zeros((n,) + src.shape[1:], dtype=src.dtype)
    return out.index_add_(0, seg, src)
def _pad(x, pw):
    flat = tuple(v for pair in reversed(pw) for v in pair)
    return torch.nn.functional.pad(x, flat)

kernel_name = 'recurrent_scan__gqa_block_cached__swiglu_ffn__decode'

def setup_inputs():

    _w = (lambda a: (lambda t: t.to(torch.bfloat16) if t.is_floating_point() else t)(torch.as_tensor(a)))
    def _A_setup():
        B, Sq, D = 4, 1, 512
        Hq, Hkv, Sk, Dh = 32, 8, 4096, 128
        assert Hq % Hkv == 0, (Hq, Hkv)
        return {
            "x": _w((lambda *s: torch.randn(*s, dtype=torch.bfloat16) * 0.05)(B, Sq, D)),
            "k_cache": _w((lambda *s: torch.randn(*s, dtype=torch.bfloat16) * 1.6)(B, Hkv, Sk, Dh)),
            "v_cache": _w((lambda *s: torch.randn(*s, dtype=torch.bfloat16) * 0.2)(B, Hkv, Sk, Dh)),
            "wq": _w((lambda *s: torch.randn(*s, dtype=torch.bfloat16) * 1.6)(D, Hq * Dh) * (D ** -0.5)),
            "wo": _w((lambda *s: torch.randn(*s, dtype=torch.bfloat16) * 0.2)(Hq * Dh, D) * ((Hq * Dh) ** -0.5)),
        }
    _A_in = _A_setup()

    def _B_setup():
        B, S, D, F = 4, 1, 512, 1792
        return {
            "x": _w((lambda *s: torch.randn(*s, dtype=torch.bfloat16) * 0.05)(B, S, D)),
            "w_gate": _w((lambda *s: torch.randn(*s, dtype=torch.bfloat16) * 0.1)(D, F)),
            "w_up": _w((lambda *s: torch.randn(*s, dtype=torch.bfloat16) * 0.1)(D, F)),
            "w_down": _w((lambda *s: torch.randn(*s, dtype=torch.bfloat16) * 0.1)(F, D)),
        }
    _B_in = _B_setup()

    return {
        "A_x": _A_in["x"],
        "A_k_cache": _A_in["k_cache"],
        "A_v_cache": _A_in["v_cache"],
        "A_wq": _A_in["wq"],
        "A_wo": _A_in["wo"],
        "B_x": _B_in["x"],
        "B_w_gate": _B_in["w_gate"],
        "B_w_up": _B_in["w_up"],
        "B_w_down": _B_in["w_down"],
    }

def reference(A_x, A_k_cache, A_v_cache, A_wq, A_wo, B_x, B_w_gate, B_w_up, B_w_down):
    def _A_ref(x, k_cache, v_cache, wq, wo):
        B, Sq, D = x.shape
        Hq, Dh = 32, 128
        Hkv = k_cache.shape[1]
        rep = Hq // Hkv
        q = (lambda x, *d: x.permute(*d))((x @ wq).reshape(B, Sq, Hq, Dh), 0, 2, 1, 3)
        k = (lambda x, n, axis: torch.repeat_interleave(x, n, dim=axis))(k_cache, rep, axis=1)
        v = (lambda x, n, axis: torch.repeat_interleave(x, n, dim=axis))(v_cache, rep, axis=1)
        scores = torch.einsum("bhqd,bhkd->bhqk", q, k) * (Dh ** -0.5)
        p = _softmax(scores, axis=-1)
        o = torch.einsum("bhqk,bhkd->bhqd", p, v)
        return (lambda x, *d: x.permute(*d))(o, 0, 2, 1, 3).reshape(B, Sq, Hq * Dh) @ wo

    def _B_ref(x, w_gate, w_up, w_down):
        g = _silu(x @ w_gate)
        u = x @ w_up
        return (g * u) @ w_down

    x = A_x
    xn = _layernorm(x, axis=-1)
    s = _A_ref(xn, A_k_cache, A_v_cache, A_wq, A_wo)
    g = _silu(_B_ref(xn, B_w_gate, B_w_up, B_w_down))
    return x + s * g
```

```asm
; @launch grid=(256,1,1) block=(384,1,1) lds=163840
.amdgcn_target "amdgcn-amd-amdhsa--gfx950"
.text
.globl recurrent_scan__gqa_block_cached__swiglu_ffn__decode_kernel
.p2align 8
.type recurrent_scan__gqa_block_cached__swiglu_ffn__decode_kernel,@function
recurrent_scan__gqa_block_cached__swiglu_ffn__decode_kernel:
s_cmp_ge_u32 s2, 256
s_cbranch_scc0 L_start
s_endpgm
L_start:
s_load_dwordx16 s[8:23], s[0:1], 0
s_load_dwordx8 s[24:31], s[0:1], 64
v_lshrrev_b32 v1, 6, v0
v_and_b32 v0, 63, v0
v_readfirstlane_b32 s3, v1
s_lshr_b32 s33, s2, 3
s_and_b32 s32, s2, 7
s_lshr_b32 s34, s33, 3
s_and_b32 s35, s33, 7
s_lshl_b32 s70, s32, 3
s_add_u32 s70, s70, s35
s_mov_b32 s39, 0
s_mov_b32 s68, 0xfffffff0
s_cmp_eq_u32 s3, 4
s_cbranch_scc1 L_loader
s_cmp_lg_u32 s3, 5
s_cbranch_scc1 nopf_1
s_getpc_b64 s[4:5]
L_pc:
s_lshl_b32 s6, s33, 10
v_lshl_add_u32 v1, v0, 4, s6
s_mov_b32 s7, L_code_end-L_pc-16
v_min_u32 v1, s7, v1
global_load_dwordx4 v[232:235], v1, s[4:5]
nopf_1:
s_cmp_eq_u32 s3, 5
s_cbranch_scc1 L_service
s_nop 3
s_lshl_b32 s72, s3, 10
v_lshlrev_b32 v8, 4, v0
v_add_u32 v9, s72, v8
s_waitcnt lgkmcnt(0)
global_load_dwordx4 v[12:15], v9, s[8:9]
s_load_dword s71, s[30:31], 0
v_mov_b32 v2, 159488
v_mov_b32 v3, 1
v_and_b32 v10, 15, v0
v_lshrrev_b32 v11, 4, v0
s_barrier
s_waitcnt vmcnt(0)
v_lshlrev_b32 v16, 16, v12
v_and_b32 v17, 0xffff0000, v12
v_lshlrev_b32 v18, 16, v13
v_and_b32 v19, 0xffff0000, v13
v_lshlrev_b32 v20, 16, v14
v_and_b32 v21, 0xffff0000, v14
v_lshlrev_b32 v22, 16, v15
v_and_b32 v23, 0xffff0000, v15
v_add_f32 v24, v16, v17
v_add_f32 v25, v18, v19
v_add_f32 v26, v20, v21
v_add_f32 v27, v22, v23
v_add_f32 v24, v24, v25
v_add_f32 v26, v26, v27
v_add_f32 v24, v24, v26
s_nop 1
v_add_f32_dpp v24, v24, v24 row_ror:8 row_mask:0xf bank_mask:0xf
s_nop 1
v_add_f32_dpp v24, v24, v24 row_ror:4 row_mask:0xf bank_mask:0xf
s_nop 1
v_add_f32_dpp v24, v24, v24 row_ror:2 row_mask:0xf bank_mask:0xf
s_nop 1
v_add_f32_dpp v24, v24, v24 row_ror:1 row_mask:0xf bank_mask:0xf
v_mov_b32 v25, v24
s_nop 1
v_permlane16_swap_b32 v24, v25
v_add_f32 v24, v24, v25
v_mov_b32 v25, v24
s_nop 1
v_permlane32_swap_b32 v24, v25
v_add_f32 v24, v24, v25
v_mul_f32 v24, 0x3b000000, v24
v_sub_f32 v32, v16, v24
v_sub_f32 v33, v17, v24
v_sub_f32 v34, v18, v24
v_sub_f32 v35, v19, v24
v_sub_f32 v36, v20, v24
v_sub_f32 v37, v21, v24
v_sub_f32 v38, v22, v24
v_sub_f32 v39, v23, v24
v_mul_f32 v25, v32, v32
v_mul_f32 v26, v33, v33
v_fmac_f32 v25, v34, v34
v_fmac_f32 v26, v35, v35
v_fmac_f32 v25, v36, v36
v_fmac_f32 v26, v37, v37
v_fmac_f32 v25, v38, v38
v_fmac_f32 v26, v39, v39
v_add_f32 v25, v25, v26
s_nop 1
v_add_f32_dpp v25, v25, v25 row_ror:8 row_mask:0xf bank_mask:0xf
s_nop 1
v_add_f32_dpp v25, v25, v25 row_ror:4 row_mask:0xf bank_mask:0xf
s_nop 1
v_add_f32_dpp v25, v25, v25 row_ror:2 row_mask:0xf bank_mask:0xf
s_nop 1
v_add_f32_dpp v25, v25, v25 row_ror:1 row_mask:0xf bank_mask:0xf
v_mov_b32 v26, v25
s_nop 1
v_permlane16_swap_b32 v25, v26
v_add_f32 v25, v25, v26
v_mov_b32 v26, v25
s_nop 1
v_permlane32_swap_b32 v25, v26
v_add_f32 v25, v25, v26
v_mul_f32 v25, 0x3b000000, v25
v_cvt_pk_bf16_f32 v26, v24, v25
v_lshlrev_b32 v24, 16, v26
v_and_b32 v25, 0xffff0000, v26
v_add_f32 v25, 0x3727c5ac, v25
v_cvt_pk_bf16_f32 v25, v25, v25
v_lshlrev_b32 v25, 16, v25
v_sqrt_f32 v25, v25
s_nop 0
v_cvt_pk_bf16_f32 v25, v25, v25
v_lshlrev_b32 v25, 16, v25
v_rcp_f32 v27, v25
v_sub_f32 v32, v16, v24
v_sub_f32 v33, v17, v24
v_sub_f32 v34, v18, v24
v_sub_f32 v35, v19, v24
v_sub_f32 v36, v20, v24
v_sub_f32 v37, v21, v24
v_sub_f32 v38, v22, v24
v_sub_f32 v39, v23, v24
v_cvt_pk_bf16_f32 v26, v32, v33
v_lshlrev_b32 v32, 16, v26
v_and_b32 v33, 0xffff0000, v26
v_cvt_pk_bf16_f32 v26, v34, v35
v_lshlrev_b32 v34, 16, v26
v_and_b32 v35, 0xffff0000, v26
v_cvt_pk_bf16_f32 v26, v36, v37
v_lshlrev_b32 v36, 16, v26
v_and_b32 v37, 0xffff0000, v26
v_cvt_pk_bf16_f32 v26, v38, v39
v_lshlrev_b32 v38, 16, v26
v_and_b32 v39, 0xffff0000, v26
v_mul_f32 v16, v32, v27
v_mul_f32 v17, v33, v27
v_mul_f32 v18, v34, v27
v_mul_f32 v19, v35, v27
v_mul_f32 v20, v36, v27
v_mul_f32 v21, v37, v27
v_mul_f32 v22, v38, v27
v_mul_f32 v23, v39, v27
v_fma_f32 v40, -v16, v25, v32
v_fma_f32 v41, -v17, v25, v33
v_fma_f32 v42, -v18, v25, v34
v_fma_f32 v43, -v19, v25, v35
v_fma_f32 v44, -v20, v25, v36
v_fma_f32 v45, -v21, v25, v37
v_fma_f32 v46, -v22, v25, v38
v_fma_f32 v47, -v23, v25, v39
v_fmac_f32 v16, v40, v27
v_fmac_f32 v17, v41, v27
v_fmac_f32 v18, v42, v27
v_fmac_f32 v19, v43, v27
v_fmac_f32 v20, v44, v27
v_fmac_f32 v21, v45, v27
v_fmac_f32 v22, v46, v27
v_fmac_f32 v23, v47, v27
v_cvt_pk_bf16_f32 v12, v16, v17
v_cvt_pk_bf16_f32 v13, v18, v19
v_cvt_pk_bf16_f32 v14, v20, v21
v_cvt_pk_bf16_f32 v15, v22, v23
s_mul_i32 s72, s3, 1040
s_add_u32 s72, s72, 147456
v_add_u32 v9, s72, v8
ds_write_b128 v9, v[12:15]
s_mov_b64 exec, 1
ds_add_u32 v2, v3 offset:256
s_mov_b64 exec, -1
s_waitcnt lgkmcnt(0)
s_mul_i32 s36, s71, 0x9E3779B1
s_add_u32 s36, s36, 0x7F4A7C15
s_mul_i32 s37, s71, 0x85EBCA6B
s_lshr_b32 s37, s37, 28
v_mov_b32 v8, s36
v_mov_b32 v9, s37
v_xor_b32 v16, v11, v10
v_lshlrev_b32 v16, 4, v16
v_lshl_add_u32 v16, v10, 8, v16
s_lshl_b32 s72, s3, 13
v_add_u32 v16, s72, v16
v_mov_b32 v12, v16
v_xor_b32 v13, 64, v16
v_xor_b32 v14, 128, v16
v_xor_b32 v15, 192, v16
v_and_b32 v17, 3, v10
v_mul_u32_u24 v16, 320, v17
v_lshl_add_u32 v16, v11, 4, v16
v_add_u32 v16, 151680, v16
s_mov_b32 s78, 0
s_lshl_b32 s72, s34, 3
s_add_u32 s72, s72, s32
s_lshl_b32 s72, s72, 2
s_add_u32 s72, s72, s3
s_lshl_b32 s72, s72, 12
s_add_u32 s72, s72, 524288
v_lshlrev_b32 v18, 4, v0
v_add_u32 v18, s72, v18
s_cmp_ge_u32 s78, 16
s_cbranch_scc1 have_2
spin_3:
ds_read_b32 v4, v2 offset:0
s_waitcnt lgkmcnt(0)
v_readfirstlane_b32 s78, v4
s_nop 0
s_cmp_ge_u32 s78, 16
s_cbranch_scc1 done_4
s_sleep 1
s_add_u32 s39, s39, 1
s_cmp_lt_u32 s39, 262144
s_cbranch_scc1 spin_3
done_4:
have_2:
spin_5:
ds_read_b32 v4, v2 offset:260
s_waitcnt lgkmcnt(0)
v_readfirstlane_b32 s77, v4
s_nop 0
s_cmp_ge_u32 s77, 1
s_cbranch_scc1 done_6
s_sleep 1
s_add_u32 s39, s39, 1
s_cmp_lt_u32 s39, 262144
s_cbranch_scc1 spin_5
done_6:
poll_7:
global_load_dwordx4 v[36:39], v18, s[30:31] offset:0 sc1
global_load_dwordx4 v[40:43], v18, s[30:31] offset:1024 sc1
global_load_dwordx4 v[44:47], v18, s[30:31] offset:2048 sc1
global_load_dwordx4 v[48:51], v18, s[30:31] offset:3072 sc1
s_waitcnt vmcnt(0)
v_bitop3_b32 v54, v36, v38, s37 bitop3:0x7e
v_bitop3_b32 v52, v37, v39, s36 bitop3:0x7e
v_and_or_b32 v52, v54, 15, v52
v_bitop3_b32 v54, v40, v42, s37 bitop3:0x7e
v_bitop3_b32 v53, v41, v43, s36 bitop3:0x7e
v_and_or_b32 v53, v54, 15, v53
v_or_b32 v52, v52, v53
v_bitop3_b32 v54, v44, v46, s37 bitop3:0x7e
v_bitop3_b32 v53, v45, v47, s36 bitop3:0x7e
v_and_or_b32 v53, v54, 15, v53
v_or_b32 v52, v52, v53
v_bitop3_b32 v54, v48, v50, s37 bitop3:0x7e
v_bitop3_b32 v53, v49, v51, s36 bitop3:0x7e
v_and_or_b32 v53, v54, 15, v53
v_or_b32 v52, v52, v53
v_cmp_ne_u32 vcc, 0, v52
s_nop 0
s_cmp_eq_u64 vcc, 0
s_cbranch_scc1 pdone_8
s_sleep 8
s_add_u32 s39, s39, 1
s_cmp_lt_u32 s39, 262144
s_cbranch_scc1 poll_7
pdone_8:
v_and_b32 v36, s68, v36
v_and_b32 v38, s68, v38
v_and_b32 v40, s68, v40
v_and_b32 v42, s68, v42
v_and_b32 v44, s68, v44
v_and_b32 v46, s68, v46
v_and_b32 v48, s68, v48
v_and_b32 v50, s68, v50
v_add_f32 v36, v36, v40
v_add_f32 v38, v38, v42
v_add_f32 v44, v44, v48
v_add_f32 v46, v46, v50
v_add_f32 v36, v36, v44
v_add_f32 v38, v38, v46
v_cvt_pk_bf16_f32 v36, v36, v38
s_mul_i32 s72, s3, 320
s_add_u32 s72, s72, 151680
v_lshrrev_b32 v18, 5, v0
v_lshlrev_b32 v18, 7, v18
v_and_b32 v37, 15, v0
v_lshl_add_u32 v18, v37, 3, v18
v_bfe_u32 v37, v0, 4, 1
v_lshl_add_u32 v18, v37, 2, v18
v_add_u32 v18, s72, v18
ds_write_b32 v18, v36
s_mov_b64 exec, 1
ds_add_u32 v2, v3 offset:268
s_mov_b64 exec, -1
spin_9:
ds_read_b32 v4, v2 offset:268
s_waitcnt lgkmcnt(0)
v_readfirstlane_b32 s77, v4
s_nop 0
s_cmp_ge_u32 s77, 4
s_cbranch_scc1 done_10
s_add_u32 s39, s39, 1
s_cmp_lt_u32 s39, 262144
s_cbranch_scc1 spin_9
done_10:
ds_read_b128 v[20:23], v16 offset:0
ds_read_b128 v[24:27], v16 offset:64
ds_read_b128 v[28:31], v16 offset:128
ds_read_b128 v[32:35], v16 offset:192
s_lshl_b32 s79, s3, 1
s_add_u32 s79, s79, 10
s_cmp_ge_u32 s78, s79
s_cbranch_scc1 have_11
spin_12:
ds_read_b32 v4, v2 offset:0
s_waitcnt lgkmcnt(0)
v_readfirstlane_b32 s78, v4
s_nop 0
s_cmp_ge_u32 s78, s79
s_cbranch_scc1 done_13
s_sleep 1
s_add_u32 s39, s39, 1
s_cmp_lt_u32 s39, 262144
s_cbranch_scc1 spin_12
done_13:
have_11:
ds_read_b128 v[36:39], v12 offset:0
ds_read_b128 v[40:43], v13 offset:0
ds_read_b128 v[44:47], v14 offset:0
ds_read_b128 v[48:51], v15 offset:0
ds_read_b128 v[52:55], v12 offset:4096
ds_read_b128 v[56:59], v13 offset:4096
ds_read_b128 v[60:63], v14 offset:4096
ds_read_b128 v[64:67], v15 offset:4096
s_waitcnt lgkmcnt(4)
v_mfma_f32_16x16x32_bf16 v[68:71], v[36:39], v[20:23], 0
v_mfma_f32_16x16x32_bf16 v[68:71], v[40:43], v[24:27], v[68:71]
v_mfma_f32_16x16x32_bf16 v[68:71], v[44:47], v[28:31], v[68:71]
v_mfma_f32_16x16x32_bf16 v[68:71], v[48:51], v[32:35], v[68:71]
s_waitcnt lgkmcnt(0)
v_mfma_f32_16x16x32_bf16 v[72:75], v[52:55], v[20:23], 0
v_mfma_f32_16x16x32_bf16 v[72:75], v[56:59], v[24:27], v[72:75]
v_mfma_f32_16x16x32_bf16 v[72:75], v[60:63], v[28:31], v[72:75]
v_mfma_f32_16x16x32_bf16 v[72:75], v[64:67], v[32:35], v[72:75]
s_lshl_b32 s72, s3, 2
s_add_u32 s72, s72, 159776
v_mov_b32 v5, s72
v_mov_b32 v6, 1
ds_write_b32 v5, v6
s_lshl_b32 s79, s3, 1
s_add_u32 s79, s79, 20
s_cmp_ge_u32 s78, s79
s_cbranch_scc1 have_14
spin_15:
ds_read_b32 v4, v2 offset:0
s_waitcnt lgkmcnt(0)
v_readfirstlane_b32 s78, v4
s_nop 0
s_cmp_ge_u32 s78, s79
s_cbranch_scc1 done_16
s_sleep 1
s_add_u32 s39, s39, 1
s_cmp_lt_u32 s39, 262144
s_cbranch_scc1 spin_15
done_16:
have_14:
ds_read_b128 v[36:39], v12 offset:32768
ds_read_b128 v[40:43], v13 offset:32768
ds_read_b128 v[44:47], v14 offset:32768
ds_read_b128 v[48:51], v15 offset:32768
ds_read_b128 v[52:55], v12 offset:36864
ds_read_b128 v[56:59], v13 offset:36864
ds_read_b128 v[60:63], v14 offset:36864
ds_read_b128 v[64:67], v15 offset:36864
s_waitcnt lgkmcnt(4)
v_mfma_f32_16x16x32_bf16 v[76:79], v[36:39], v[20:23], 0
v_mfma_f32_16x16x32_bf16 v[76:79], v[40:43], v[24:27], v[76:79]
v_mfma_f32_16x16x32_bf16 v[76:79], v[44:47], v[28:31], v[76:79]
v_mfma_f32_16x16x32_bf16 v[76:79], v[48:51], v[32:35], v[76:79]
s_waitcnt lgkmcnt(0)
v_mfma_f32_16x16x32_bf16 v[80:83], v[52:55], v[20:23], 0
v_mfma_f32_16x16x32_bf16 v[80:83], v[56:59], v[24:27], v[80:83]
v_mfma_f32_16x16x32_bf16 v[80:83], v[60:63], v[28:31], v[80:83]
v_mfma_f32_16x16x32_bf16 v[80:83], v[64:67], v[32:35], v[80:83]
s_lshl_b32 s72, s3, 2
s_add_u32 s72, s72, 159776
v_mov_b32 v5, s72
v_mov_b32 v6, 2
ds_write_b32 v5, v6
v_add_u32 v12, 0x10000, v12
v_add_u32 v13, 0x10000, v13
v_add_u32 v14, 0x10000, v14
v_add_u32 v15, 0x10000, v15
s_lshl_b32 s79, s3, 1
s_add_u32 s79, s79, 28
s_cmp_ge_u32 s78, s79
s_cbranch_scc1 have_17
spin_18:
ds_read_b32 v4, v2 offset:0
s_waitcnt lgkmcnt(0)
v_readfirstlane_b32 s78, v4
s_nop 0
s_cmp_ge_u32 s78, s79
s_cbranch_scc1 done_19
s_sleep 1
s_add_u32 s39, s39, 1
s_cmp_lt_u32 s39, 262144
s_cbranch_scc1 spin_18
done_19:
have_17:
ds_read_b128 v[36:39], v12 offset:0
ds_read_b128 v[40:43], v13 offset:0
ds_read_b128 v[44:47], v14 offset:0
ds_read_b128 v[48:51], v15 offset:0
ds_read_b128 v[52:55], v12 offset:4096
ds_read_b128 v[56:59], v13 offset:4096
ds_read_b128 v[60:63], v14 offset:4096
ds_read_b128 v[64:67], v15 offset:4096
s_waitcnt lgkmcnt(4)
v_mfma_f32_16x16x32_bf16 v[84:87], v[36:39], v[20:23], 0
v_mfma_f32_16x16x32_bf16 v[84:87], v[40:43], v[24:27], v[84:87]
v_mfma_f32_16x16x32_bf16 v[84:87], v[44:47], v[28:31], v[84:87]
v_mfma_f32_16x16x32_bf16 v[84:87], v[48:51], v[32:35], v[84:87]
s_waitcnt lgkmcnt(0)
v_mfma_f32_16x16x32_bf16 v[88:91], v[52:55], v[20:23], 0
v_mfma_f32_16x16x32_bf16 v[88:91], v[56:59], v[24:27], v[88:91]
v_mfma_f32_16x16x32_bf16 v[88:91], v[60:63], v[28:31], v[88:91]
v_mfma_f32_16x16x32_bf16 v[88:91], v[64:67], v[32:35], v[88:91]
s_lshl_b32 s72, s3, 2
s_add_u32 s72, s72, 159776
v_mov_b32 v5, s72
v_mov_b32 v6, 3
ds_write_b32 v5, v6
s_lshl_b32 s79, s3, 1
s_add_u32 s79, s79, 36
s_cmp_ge_u32 s78, s79
s_cbranch_scc1 have_20
spin_21:
ds_read_b32 v4, v2 offset:0
s_waitcnt lgkmcnt(0)
v_readfirstlane_b32 s78, v4
s_nop 0
s_cmp_ge_u32 s78, s79
s_cbranch_scc1 done_22
s_sleep 1
s_add_u32 s39, s39, 1
s_cmp_lt_u32 s39, 262144
s_cbranch_scc1 spin_21
done_22:
have_20:
ds_read_b128 v[36:39], v12 offset:32768
ds_read_b128 v[40:43], v13 offset:32768
ds_read_b128 v[44:47], v14 offset:32768
ds_read_b128 v[48:51], v15 offset:32768
ds_read_b128 v[52:55], v12 offset:36864
ds_read_b128 v[56:59], v13 offset:36864
ds_read_b128 v[60:63], v14 offset:36864
ds_read_b128 v[64:67], v15 offset:36864
s_waitcnt lgkmcnt(4)
v_mfma_f32_16x16x32_bf16 v[92:95], v[36:39], v[20:23], 0
v_mfma_f32_16x16x32_bf16 v[92:95], v[40:43], v[24:27], v[92:95]
v_mfma_f32_16x16x32_bf16 v[92:95], v[44:47], v[28:31], v[92:95]
v_mfma_f32_16x16x32_bf16 v[92:95], v[48:51], v[32:35], v[92:95]
s_waitcnt lgkmcnt(0)
v_mfma_f32_16x16x32_bf16 v[96:99], v[52:55], v[20:23], 0
v_mfma_f32_16x16x32_bf16 v[96:99], v[56:59], v[24:27], v[96:99]
v_mfma_f32_16x16x32_bf16 v[96:99], v[60:63], v[28:31], v[96:99]
v_mfma_f32_16x16x32_bf16 v[96:99], v[64:67], v[32:35], v[96:99]
s_lshl_b32 s72, s3, 2
s_add_u32 s72, s72, 159776
v_mov_b32 v5, s72
v_mov_b32 v6, 4
ds_write_b32 v5, v6
v_cvt_pk_bf16_f32 v36, v68, v69
v_lshlrev_b32 v68, 16, v36
v_and_b32 v69, 0xffff0000, v36
v_cvt_pk_bf16_f32 v37, v70, v71
v_lshlrev_b32 v70, 16, v37
v_and_b32 v71, 0xffff0000, v37
v_cvt_pk_bf16_f32 v38, v72, v73
v_lshlrev_b32 v72, 16, v38
v_and_b32 v73, 0xffff0000, v38
v_cvt_pk_bf16_f32 v39, v74, v75
v_lshlrev_b32 v74, 16, v39
v_and_b32 v75, 0xffff0000, v39
v_cvt_pk_bf16_f32 v40, v76, v77
v_lshlrev_b32 v76, 16, v40
v_and_b32 v77, 0xffff0000, v40
v_cvt_pk_bf16_f32 v41, v78, v79
v_lshlrev_b32 v78, 16, v41
v_and_b32 v79, 0xffff0000, v41
v_cvt_pk_bf16_f32 v42, v80, v81
v_lshlrev_b32 v80, 16, v42
v_and_b32 v81, 0xffff0000, v42
v_cvt_pk_bf16_f32 v43, v82, v83
v_lshlrev_b32 v82, 16, v43
v_and_b32 v83, 0xffff0000, v43
v_cvt_pk_bf16_f32 v36, v84, v85
v_lshlrev_b32 v84, 16, v36
v_and_b32 v85, 0xffff0000, v36
v_cvt_pk_bf16_f32 v37, v86, v87
v_lshlrev_b32 v86, 16, v37
v_and_b32 v87, 0xffff0000, v37
v_cvt_pk_bf16_f32 v38, v88, v89
v_lshlrev_b32 v88, 16, v38
v_and_b32 v89, 0xffff0000, v38
v_cvt_pk_bf16_f32 v39, v90, v91
v_lshlrev_b32 v90, 16, v39
v_and_b32 v91, 0xffff0000, v39
v_cvt_pk_bf16_f32 v40, v92, v93
v_lshlrev_b32 v92, 16, v40
v_and_b32 v93, 0xffff0000, v40
v_cvt_pk_bf16_f32 v41, v94, v95
v_lshlrev_b32 v94, 16, v41
v_and_b32 v95, 0xffff0000, v41
v_cvt_pk_bf16_f32 v42, v96, v97
v_lshlrev_b32 v96, 16, v42
v_and_b32 v97, 0xffff0000, v42
v_cvt_pk_bf16_f32 v43, v98, v99
v_lshlrev_b32 v98, 16, v43
v_and_b32 v99, 0xffff0000, v43
v_mul_f32 v68, 0x3db504f3, v68
v_mul_f32 v69, 0x3db504f3, v69
v_mul_f32 v70, 0x3db504f3, v70
v_mul_f32 v71, 0x3db504f3, v71
v_mul_f32 v72, 0x3db504f3, v72
v_mul_f32 v73, 0x3db504f3, v73
v_mul_f32 v74, 0x3db504f3, v74
v_mul_f32 v75, 0x3db504f3, v75
v_mul_f32 v76, 0x3db504f3, v76
v_mul_f32 v77, 0x3db504f3, v77
v_mul_f32 v78, 0x3db504f3, v78
v_mul_f32 v79, 0x3db504f3, v79
v_mul_f32 v80, 0x3db504f3, v80
v_mul_f32 v81, 0x3db504f3, v81
v_mul_f32 v82, 0x3db504f3, v82
v_mul_f32 v83, 0x3db504f3, v83
v_mul_f32 v84, 0x3db504f3, v84
v_mul_f32 v85, 0x3db504f3, v85
v_mul_f32 v86, 0x3db504f3, v86
v_mul_f32 v87, 0x3db504f3, v87
v_mul_f32 v88, 0x3db504f3, v88
v_mul_f32 v89, 0x3db504f3, v89
v_mul_f32 v90, 0x3db504f3, v90
v_mul_f32 v91, 0x3db504f3, v91
v_mul_f32 v92, 0x3db504f3, v92
v_mul_f32 v93, 0x3db504f3, v93
v_mul_f32 v94, 0x3db504f3, v94
v_mul_f32 v95, 0x3db504f3, v95
v_mul_f32 v96, 0x3db504f3, v96
v_mul_f32 v97, 0x3db504f3, v97
v_mul_f32 v98, 0x3db504f3, v98
v_mul_f32 v99, 0x3db504f3, v99
v_cvt_pk_bf16_f32 v36, v68, v69
v_lshlrev_b32 v68, 16, v36
v_and_b32 v69, 0xffff0000, v36
v_cvt_pk_bf16_f32 v37, v70, v71
v_lshlrev_b32 v70, 16, v37
v_and_b32 v71, 0xffff0000, v37
v_cvt_pk_bf16_f32 v38, v72, v73
v_lshlrev_b32 v72, 16, v38
v_and_b32 v73, 0xffff0000, v38
v_cvt_pk_bf16_f32 v39, v74, v75
v_lshlrev_b32 v74, 16, v39
v_and_b32 v75, 0xffff0000, v39
v_cvt_pk_bf16_f32 v40, v76, v77
v_lshlrev_b32 v76, 16, v40
v_and_b32 v77, 0xffff0000, v40
v_cvt_pk_bf16_f32 v41, v78, v79
v_lshlrev_b32 v78, 16, v41
v_and_b32 v79, 0xffff0000, v41
v_cvt_pk_bf16_f32 v42, v80, v81
v_lshlrev_b32 v80, 16, v42
v_and_b32 v81, 0xffff0000, v42
v_cvt_pk_bf16_f32 v43, v82, v83
v_lshlrev_b32 v82, 16, v43
v_and_b32 v83, 0xffff0000, v43
v_cvt_pk_bf16_f32 v36, v84, v85
v_lshlrev_b32 v84, 16, v36
v_and_b32 v85, 0xffff0000, v36
v_cvt_pk_bf16_f32 v37, v86, v87
v_lshlrev_b32 v86, 16, v37
v_and_b32 v87, 0xffff0000, v37
v_cvt_pk_bf16_f32 v38, v88, v89
v_lshlrev_b32 v88, 16, v38
v_and_b32 v89, 0xffff0000, v38
v_cvt_pk_bf16_f32 v39, v90, v91
v_lshlrev_b32 v90, 16, v39
v_and_b32 v91, 0xffff0000, v39
v_cvt_pk_bf16_f32 v40, v92, v93
v_lshlrev_b32 v92, 16, v40
v_and_b32 v93, 0xffff0000, v40
v_cvt_pk_bf16_f32 v41, v94, v95
v_lshlrev_b32 v94, 16, v41
v_and_b32 v95, 0xffff0000, v41
v_cvt_pk_bf16_f32 v42, v96, v97
v_lshlrev_b32 v96, 16, v42
v_and_b32 v97, 0xffff0000, v42
v_cvt_pk_bf16_f32 v43, v98, v99
v_lshlrev_b32 v98, 16, v43
v_and_b32 v99, 0xffff0000, v43
v_max3_f32 v36, v68, v69, v70
v_max3_f32 v37, v71, v72, v73
v_max3_f32 v36, v36, v74, v75
v_max3_f32 v37, v37, v76, v77
v_max3_f32 v36, v36, v78, v79
v_max3_f32 v37, v37, v80, v81
v_max3_f32 v36, v36, v82, v83
v_max3_f32 v37, v37, v84, v85
v_max3_f32 v36, v36, v86, v87
v_max3_f32 v37, v37, v88, v89
v_max3_f32 v36, v36, v90, v91
v_max3_f32 v37, v37, v92, v93
v_max3_f32 v36, v36, v94, v95
v_max3_f32 v37, v37, v96, v97
v_max3_f32 v36, v36, v98, v99
v_max_f32 v36, v36, v37
v_mov_b32 v37, v36
s_nop 1
v_permlane16_swap_b32 v36, v37
v_max_f32 v36, v36, v37
v_mov_b32 v37, v36
s_nop 1
v_permlane32_swap_b32 v36, v37
v_max_f32 v36, v36, v37
s_lshl_b32 s72, s3, 4
s_add_u32 s72, s72, 159360
v_lshl_add_u32 v38, v17, 2, s72
ds_write_b32 v38, v36
s_mov_b64 exec, 1
ds_add_u32 v2, v3 offset:272
s_mov_b64 exec, -1
spin_23:
ds_read_b32 v4, v2 offset:272
s_waitcnt lgkmcnt(0)
v_readfirstlane_b32 s77, v4
s_nop 0
s_cmp_ge_u32 s77, 4
s_cbranch_scc1 done_24
s_add_u32 s39, s39, 1
s_cmp_lt_u32 s39, 262144
s_cbranch_scc1 spin_23
done_24:
v_lshlrev_b32 v39, 2, v17
v_add_u32 v39, 159360, v39
ds_read_b32 v40, v39 offset:0
ds_read_b32 v41, v39 offset:16
ds_read_b32 v42, v39 offset:32
ds_read_b32 v43, v39 offset:48
s_waitcnt lgkmcnt(0)
v_max_f32 v40, v40, v41
v_max3_f32 v40, v40, v42, v43
s_mov_b32 s72, 0x3fb8aa3b
v_mul_f32 v40, s72, v40
v_fma_f32 v68, v68, s72, -v40
v_fma_f32 v69, v69, s72, -v40
v_fma_f32 v70, v70, s72, -v40
v_fma_f32 v71, v71, s72, -v40
v_fma_f32 v72, v72, s72, -v40
v_fma_f32 v73, v73, s72, -v40
v_fma_f32 v74, v74, s72, -v40
v_fma_f32 v75, v75, s72, -v40
v_fma_f32 v76, v76, s72, -v40
v_fma_f32 v77, v77, s72, -v40
v_fma_f32 v78, v78, s72, -v40
v_fma_f32 v79, v79, s72, -v40
v_fma_f32 v80, v80, s72, -v40
v_fma_f32 v81, v81, s72, -v40
v_fma_f32 v82, v82, s72, -v40
v_fma_f32 v83, v83, s72, -v40
v_fma_f32 v84, v84, s72, -v40
v_fma_f32 v85, v85, s72, -v40
v_fma_f32 v86, v86, s72, -v40
v_fma_f32 v87, v87, s72, -v40
v_fma_f32 v88, v88, s72, -v40
v_fma_f32 v89, v89, s72, -v40
v_fma_f32 v90, v90, s72, -v40
v_fma_f32 v91, v91, s72, -v40
v_fma_f32 v92, v92, s72, -v40
v_fma_f32 v93, v93, s72, -v40
v_fma_f32 v94, v94, s72, -v40
v_fma_f32 v95, v95, s72, -v40
v_fma_f32 v96, v96, s72, -v40
v_fma_f32 v97, v97, s72, -v40
v_fma_f32 v98, v98, s72, -v40
v_fma_f32 v99, v99, s72, -v40
v_exp_f32 v68, v68
v_exp_f32 v69, v69
v_exp_f32 v70, v70
v_exp_f32 v71, v71
v_exp_f32 v72, v72
v_exp_f32 v73, v73
v_exp_f32 v74, v74
v_exp_f32 v75, v75
v_exp_f32 v76, v76
v_exp_f32 v77, v77
v_exp_f32 v78, v78
v_exp_f32 v79, v79
v_exp_f32 v80, v80
v_exp_f32 v81, v81
v_exp_f32 v82, v82
v_exp_f32 v83, v83
v_exp_f32 v84, v84
v_exp_f32 v85, v85
v_exp_f32 v86, v86
v_exp_f32 v87, v87
v_exp_f32 v88, v88
v_exp_f32 v89, v89
v_exp_f32 v90, v90
v_exp_f32 v91, v91
v_exp_f32 v92, v92
v_exp_f32 v93, v93
v_exp_f32 v94, v94
v_exp_f32 v95, v95
v_exp_f32 v96, v96
v_exp_f32 v97, v97
v_exp_f32 v98, v98
v_exp_f32 v99, v99
v_add_f32 v41, v68, v69
v_add_f32 v42, v70, v71
v_add_f32 v41, v41, v72
v_add_f32 v41, v41, v73
v_add_f32 v42, v42, v74
v_add_f32 v42, v42, v75
v_add_f32 v41, v41, v76
v_add_f32 v41, v41, v77
v_add_f32 v42, v42, v78
v_add_f32 v42, v42, v79
v_add_f32 v41, v41, v80
v_add_f32 v41, v41, v81
v_add_f32 v42, v42, v82
v_add_f32 v42, v42, v83
v_add_f32 v41, v41, v84
v_add_f32 v41, v41, v85
v_add_f32 v42, v42, v86
v_add_f32 v42, v42, v87
v_add_f32 v41, v41, v88
v_add_f32 v41, v41, v89
v_add_f32 v42, v42, v90
v_add_f32 v42, v42, v91
v_add_f32 v41, v41, v92
v_add_f32 v41, v41, v93
v_add_f32 v42, v42, v94
v_add_f32 v42, v42, v95
v_add_f32 v41, v41, v96
v_add_f32 v41, v41, v97
v_add_f32 v42, v42, v98
v_add_f32 v42, v42, v99
v_add_f32 v41, v41, v42
v_mov_b32 v42, v41
s_nop 1
v_permlane16_swap_b32 v41, v42
v_add_f32 v41, v41, v42
v_mov_b32 v42, v41
s_nop 1
v_permlane32_swap_b32 v41, v42
v_add_f32 v41, v41, v42
ds_write_b32 v38, v41 offset:64
v_cvt_pk_bf16_f32 v36, v68, v69
v_cvt_pk_bf16_f32 v37, v70, v71
v_cvt_pk_bf16_f32 v38, v72, v73
v_cvt_pk_bf16_f32 v39, v74, v75
v_cvt_pk_bf16_f32 v40, v76, v77
v_cvt_pk_bf16_f32 v41, v78, v79
v_cvt_pk_bf16_f32 v42, v80, v81
v_cvt_pk_bf16_f32 v43, v82, v83
v_cvt_pk_bf16_f32 v44, v84, v85
v_cvt_pk_bf16_f32 v45, v86, v87
v_cvt_pk_bf16_f32 v46, v88, v89
v_cvt_pk_bf16_f32 v47, v90, v91
v_cvt_pk_bf16_f32 v48, v92, v93
v_cvt_pk_bf16_f32 v49, v94, v95
v_cvt_pk_bf16_f32 v50, v96, v97
v_cvt_pk_bf16_f32 v51, v98, v99
v_lshlrev_b32 v32, 6, v11
v_lshl_add_u32 v32, v10, 4, v32
s_lshl_b32 s72, s3, 8
s_add_u32 s72, s72, 154880
v_add_u32 v33, s72, v32
s_mov_b32 exec_lo, 0x000f000f
s_mov_b32 exec_hi, 0x000f000f
ds_write_b128 v33, v[36:39] offset:0
ds_write_b128 v33, v[40:43] offset:1024
ds_write_b128 v33, v[44:47] offset:2048
ds_write_b128 v33, v[48:51] offset:3072
s_mov_b64 exec, -1
s_mov_b64 exec, 1
ds_add_u32 v2, v3 offset:276
s_mov_b64 exec, -1
v_lshrrev_b32 v14, 2, v0
v_and_b32 v15, 7, v14
s_lshl_b32 s72, s3, 1
v_xor_b32 v15, s72, v15
v_lshlrev_b32 v15, 5, v15
v_lshl_add_u32 v15, v14, 8, v15
v_and_b32 v14, 3, v0
v_lshl_add_u32 v12, v14, 3, v15
v_xor_b32 v13, 32, v12
v_lshlrev_b32 v34, 6, v11
v_lshl_add_u32 v34, v17, 4, v34
v_add_u32 v34, 154880, v34
spin_25:
ds_read_b32 v4, v2 offset:276
s_waitcnt lgkmcnt(0)
v_readfirstlane_b32 s77, v4
s_nop 0
s_cmp_ge_u32 s77, 4
s_cbranch_scc1 done_26
s_add_u32 s39, s39, 1
s_cmp_lt_u32 s39, 262144
s_cbranch_scc1 spin_25
done_26:
ds_read_b128 v[100:103], v34 offset:0
ds_read_b128 v[104:107], v34 offset:256
ds_read_b128 v[108:111], v34 offset:512
ds_read_b128 v[112:115], v34 offset:768
ds_read_b128 v[116:119], v34 offset:1024
ds_read_b128 v[120:123], v34 offset:1280
ds_read_b128 v[124:127], v34 offset:1536
ds_read_b128 v[128:131], v34 offset:1792
s_waitcnt lgkmcnt(0)
ds_read_b128 v[132:135], v34 offset:2048
ds_read_b128 v[136:139], v34 offset:2304
ds_read_b128 v[140:143], v34 offset:2560
ds_read_b128 v[144:147], v34 offset:2816
ds_read_b128 v[148:151], v34 offset:3072
ds_read_b128 v[152:155], v34 offset:3328
ds_read_b128 v[156:159], v34 offset:3584
ds_read_b128 v[160:163], v34 offset:3840
s_waitcnt lgkmcnt(0)
s_lshl_b32 s72, s34, 3
s_add_u32 s72, s72, s32
s_lshl_b32 s79, s72, 15
s_add_u32 s79, s79, 2097152
s_lshr_b32 s73, s3, 1
s_lshl_b32 s73, s73, 12
s_lshl_b32 s74, s35, 9
s_add_u32 s73, s73, s74
s_and_b32 s74, s3, 1
s_lshl_b32 s74, s74, 8
s_add_u32 s73, s73, s74
s_add_u32 s73, s73, s79
v_lshlrev_b32 v14, 13, v17
v_lshrrev_b32 v28, 2, v10
v_lshrrev_b32 v29, 1, v28
v_lshl_add_u32 v14, v29, 7, v14
v_and_b32 v29, 1, v28
v_lshl_add_u32 v14, v29, 4, v14
v_lshl_add_u32 v14, v11, 5, v14
v_add_u32 v14, s73, v14
s_lshl_b32 s73, s35, 12
s_lshl_b32 s74, s3, 7
s_add_u32 s73, s73, s74
s_add_u32 s73, s73, s79
v_lshrrev_b32 v28, 3, v0
v_lshlrev_b32 v15, 9, v28
v_and_b32 v28, 7, v0
v_lshl_add_u32 v15, v28, 4, v15
v_add_u32 v15, s73, v15
s_lshr_b32 s73, s3, 1
s_lshl_b32 s73, s73, 6
s_and_b32 s74, s3, 1
s_lshl_b32 s74, s74, 3
s_add_u32 s73, s73, s74
s_add_u32 s73, s73, 158976
v_lshrrev_b32 v29, 1, v28
v_lshlrev_b32 v18, 4, v29
v_and_b32 v29, 1, v28
v_lshl_add_u32 v18, v29, 2, v18
v_lshrrev_b32 v29, 5, v0
v_lshl_add_u32 v18, v29, 1, v18
v_add_u32 v18, s73, v18
v_lshlrev_b32 v19, 4, v11
v_add_u32 v19, 158976, v19
s_lshl_b32 s73, s34, 6
s_lshl_b32 s74, s3, 4
s_add_u32 s73, s73, s74
s_lshl_b32 s73, s73, 12
s_lshl_b32 s74, s70, 6
s_add_u32 s73, s73, s74
s_add_u32 s73, s73, 3145728
v_lshrrev_b32 v28, 2, v0
v_lshlrev_b32 v16, 12, v28
v_and_b32 v29, 3, v0
v_lshl_add_u32 v16, v29, 4, v16
v_add_u32 v16, s73, v16
v_and_b32 v30, 7, v28
v_lshlrev_b32 v31, 10, v28
v_lshl_add_u32 v31, v29, 3, v31
s_lshl_b32 s73, s3, 8
s_add_u32 s73, s73, 65536
v_add_u32 v31, s73, v31
v_xor_b32 v32, 0, v30
v_lshl_add_u32 v20, v32, 5, v31
v_xor_b32 v32, 1, v30
v_lshl_add_u32 v21, v32, 5, v31
v_xor_b32 v32, 2, v30
v_lshl_add_u32 v22, v32, 5, v31
v_xor_b32 v32, 3, v30
v_lshl_add_u32 v23, v32, 5, v31
v_xor_b32 v32, 4, v30
v_lshl_add_u32 v24, v32, 5, v31
v_xor_b32 v32, 5, v30
v_lshl_add_u32 v25, v32, 5, v31
v_xor_b32 v32, 6, v30
v_lshl_add_u32 v26, v32, 5, v31
v_xor_b32 v32, 7, v30
v_lshl_add_u32 v27, v32, 5, v31
global_load_dwordx4 v[36:39], v15, s[30:31] sc1
s_cmp_ge_u32 s78, 44
s_cbranch_scc1 have_27
spin_28:
ds_read_b32 v4, v2 offset:0
s_waitcnt lgkmcnt(0)
v_readfirstlane_b32 s78, v4
s_nop 0
s_cmp_ge_u32 s78, 44
s_cbranch_scc1 done_29
s_sleep 1
s_add_u32 s39, s39, 1
s_cmp_lt_u32 s39, 262144
s_cbranch_scc1 spin_28
done_29:
have_27:
ds_read_b64_tr_b16 v[28:29], v12 offset:0
ds_read_b64_tr_b16 v[30:31], v12 offset:4096
ds_read_b64_tr_b16 v[32:33], v13 offset:0
ds_read_b64_tr_b16 v[34:35], v13 offset:4096
s_waitcnt lgkmcnt(2)
v_mfma_f32_16x16x32_bf16 v[44:47], v[28:31], v[100:103], 0
s_waitcnt lgkmcnt(0)
v_mfma_f32_16x16x32_bf16 v[48:51], v[32:35], v[100:103], 0
s_lshl_b32 s72, s3, 2
s_add_u32 s72, s72, 159792
v_mov_b32 v5, s72
v_mov_b32 v6, 1
ds_write_b32 v5, v6
s_cmp_ge_u32 s78, 46
s_cbranch_scc1 have_30
spin_31:
ds_read_b32 v4, v2 offset:0
s_waitcnt lgkmcnt(0)
v_readfirstlane_b32 s78, v4
s_nop 0
s_cmp_ge_u32 s78, 46
s_cbranch_scc1 done_32
s_sleep 1
s_add_u32 s39, s39, 1
s_cmp_lt_u32 s39, 262144
s_cbranch_scc1 spin_31
done_32:
have_30:
ds_read_b64_tr_b16 v[28:29], v12 offset:8192
ds_read_b64_tr_b16 v[30:31], v12 offset:12288
ds_read_b64_tr_b16 v[32:33], v13 offset:8192
ds_read_b64_tr_b16 v[34:35], v13 offset:12288
s_waitcnt lgkmcnt(2)
v_mfma_f32_16x16x32_bf16 v[44:47], v[28:31], v[104:107], v[44:47]
s_waitcnt lgkmcnt(0)
v_mfma_f32_16x16x32_bf16 v[48:51], v[32:35], v[104:107], v[48:51]
s_lshl_b32 s72, s3, 2
s_add_u32 s72, s72, 159792
v_mov_b32 v5, s72
v_mov_b32 v6, 2
ds_write_b32 v5, v6
s_cmp_ge_u32 s78, 48
s_cbranch_scc1 have_33
spin_34:
ds_read_b32 v4, v2 offset:0
s_waitcnt lgkmcnt(0)
v_readfirstlane_b32 s78, v4
s_nop 0
s_cmp_ge_u32 s78, 48
s_cbranch_scc1 done_35
s_sleep 1
s_add_u32 s39, s39, 1
s_cmp_lt_u32 s39, 262144
s_cbranch_scc1 spin_34
done_35:
have_33:
ds_read_b64_tr_b16 v[28:29], v12 offset:16384
ds_read_b64_tr_b16 v[30:31], v12 offset:20480
ds_read_b64_tr_b16 v[32:33], v13 offset:16384
ds_read_b64_tr_b16 v[34:35], v13 offset:20480
s_waitcnt lgkmcnt(2)
v_mfma_f32_16x16x32_bf16 v[44:47], v[28:31], v[108:111], v[44:47]
s_waitcnt lgkmcnt(0)
v_mfma_f32_16x16x32_bf16 v[48:51], v[32:35], v[108:111], v[48:51]
s_lshl_b32 s72, s3, 2
s_add_u32 s72, s72, 159792
v_mov_b32 v5, s72
v_mov_b32 v6, 3
ds_write_b32 v5, v6
s_cmp_ge_u32 s78, 50
s_cbranch_scc1 have_36
spin_37:
ds_read_b32 v4, v2 offset:0
s_waitcnt lgkmcnt(0)
v_readfirstlane_b32 s78, v4
s_nop 0
s_cmp_ge_u32 s78, 50
s_cbranch_scc1 done_38
s_sleep 1
s_add_u32 s39, s39, 1
s_cmp_lt_u32 s39, 262144
s_cbranch_scc1 spin_37
done_38:
have_36:
ds_read_b64_tr_b16 v[28:29], v12 offset:24576
ds_read_b64_tr_b16 v[30:31], v12 offset:28672
ds_read_b64_tr_b16 v[32:33], v13 offset:24576
ds_read_b64_tr_b16 v[34:35], v13 offset:28672
s_waitcnt lgkmcnt(2)
v_mfma_f32_16x16x32_bf16 v[44:47], v[28:31], v[112:115], v[44:47]
s_waitcnt lgkmcnt(0)
v_mfma_f32_16x16x32_bf16 v[48:51], v[32:35], v[112:115], v[48:51]
s_lshl_b32 s72, s3, 2
s_add_u32 s72, s72, 159792
v_mov_b32 v5, s72
v_mov_b32 v6, 4
ds_write_b32 v5, v6
s_cmp_ge_u32 s78, 54
s_cbranch_scc1 have_39
spin_40:
ds_read_b32 v4, v2 offset:0
s_waitcnt lgkmcnt(0)
v_readfirstlane_b32 s78, v4
s_nop 0
s_cmp_ge_u32 s78, 54
s_cbranch_scc1 done_41
s_sleep 1
s_add_u32 s39, s39, 1
s_cmp_lt_u32 s39, 262144
s_cbranch_scc1 spin_40
done_41:
have_39:
ds_read_b64_tr_b16 v[28:29], v12 offset:32768
ds_read_b64_tr_b16 v[30:31], v12 offset:36864
ds_read_b64_tr_b16 v[32:33], v13 offset:32768
ds_read_b64_tr_b16 v[34:35], v13 offset:36864
s_waitcnt lgkmcnt(2)
v_mfma_f32_16x16x32_bf16 v[44:47], v[28:31], v[116:119], v[44:47]
s_waitcnt lgkmcnt(0)
v_mfma_f32_16x16x32_bf16 v[48:51], v[32:35], v[116:119], v[48:51]
s_lshl_b32 s72, s3, 2
s_add_u32 s72, s72, 159792
v_mov_b32 v5, s72
v_mov_b32 v6, 5
ds_write_b32 v5, v6
s_cmp_ge_u32 s78, 58
s_cbranch_scc1 have_42
spin_43:
ds_read_b32 v4, v2 offset:0
s_waitcnt lgkmcnt(0)
v_readfirstlane_b32 s78, v4
s_nop 0
s_cmp_ge_u32 s78, 58
s_cbranch_scc1 done_44
s_sleep 1
s_add_u32 s39, s39, 1
s_cmp_lt_u32 s39, 262144
s_cbranch_scc1 spin_43
done_44:
have_42:
ds_read_b64_tr_b16 v[28:29], v12 offset:40960
ds_read_b64_tr_b16 v[30:31], v12 offset:45056
ds_read_b64_tr_b16 v[32:33], v13 offset:40960
ds_read_b64_tr_b16 v[34:35], v13 offset:45056
s_waitcnt lgkmcnt(2)
v_mfma_f32_16x16x32_bf16 v[44:47], v[28:31], v[120:123], v[44:47]
s_waitcnt lgkmcnt(0)
v_mfma_f32_16x16x32_bf16 v[48:51], v[32:35], v[120:123], v[48:51]
s_lshl_b32 s72, s3, 2
s_add_u32 s72, s72, 159792
v_mov_b32 v5, s72
v_mov_b32 v6, 6
ds_write_b32 v5, v6
s_cmp_ge_u32 s78, 62
s_cbranch_scc1 have_45
spin_46:
ds_read_b32 v4, v2 offset:0
s_waitcnt lgkmcnt(0)
v_readfirstlane_b32 s78, v4
s_nop 0
s_cmp_ge_u32 s78, 62
s_cbranch_scc1 done_47
s_sleep 1
s_add_u32 s39, s39, 1
s_cmp_lt_u32 s39, 262144
s_cbranch_scc1 spin_46
done_47:
have_45:
ds_read_b64_tr_b16 v[28:29], v12 offset:49152
ds_read_b64_tr_b16 v[30:31], v12 offset:53248
ds_read_b64_tr_b16 v[32:33], v13 offset:49152
ds_read_b64_tr_b16 v[34:35], v13 offset:53248
s_waitcnt lgkmcnt(2)
v_mfma_f32_16x16x32_bf16 v[44:47], v[28:31], v[124:127], v[44:47]
s_waitcnt lgkmcnt(0)
v_mfma_f32_16x16x32_bf16 v[48:51], v[32:35], v[124:127], v[48:51]
s_lshl_b32 s72, s3, 2
s_add_u32 s72, s72, 159792
v_mov_b32 v5, s72
v_mov_b32 v6, 7
ds_write_b32 v5, v6
s_cmp_ge_u32 s78, 66
s_cbranch_scc1 have_48
spin_49:
ds_read_b32 v4, v2 offset:0
s_waitcnt lgkmcnt(0)
v_readfirstlane_b32 s78, v4
s_nop 0
s_cmp_ge_u32 s78, 66
s_cbranch_scc1 done_50
s_sleep 1
s_add_u32 s39, s39, 1
s_cmp_lt_u32 s39, 262144
s_cbranch_scc1 spin_49
done_50:
have_48:
ds_read_b64_tr_b16 v[28:29], v12 offset:57344
ds_read_b64_tr_b16 v[30:31], v12 offset:61440
ds_read_b64_tr_b16 v[32:33], v13 offset:57344
ds_read_b64_tr_b16 v[34:35], v13 offset:61440
s_waitcnt lgkmcnt(2)
v_mfma_f32_16x16x32_bf16 v[44:47], v[28:31], v[128:131], v[44:47]
s_waitcnt lgkmcnt(0)
v_mfma_f32_16x16x32_bf16 v[48:51], v[32:35], v[128:131], v[48:51]
s_lshl_b32 s72, s3, 2
s_add_u32 s72, s72, 159792
v_mov_b32 v5, s72
v_mov_b32 v6, 8
ds_write_b32 v5, v6
s_cmp_ge_u32 s78, 74
s_cbranch_scc1 have_51
spin_52:
ds_read_b32 v4, v2 offset:0
s_waitcnt lgkmcnt(0)
v_readfirstlane_b32 s78, v4
s_nop 0
s_cmp_ge_u32 s78, 74
s_cbranch_scc1 done_53
s_sleep 1
s_add_u32 s39, s39, 1
s_cmp_lt_u32 s39, 262144
s_cbranch_scc1 spin_52
done_53:
have_51:
ds_read_b64_tr_b16 v[28:29], v12 offset:0
ds_read_b64_tr_b16 v[30:31], v12 offset:4096
ds_read_b64_tr_b16 v[32:33], v13 offset:0
ds_read_b64_tr_b16 v[34:35], v13 offset:4096
ds_read_b64_tr_b16 v[68:69], v12 offset:8192
ds_read_b64_tr_b16 v[70:71], v12 offset:12288
ds_read_b64_tr_b16 v[72:73], v13 offset:8192
ds_read_b64_tr_b16 v[74:75], v13 offset:12288
s_waitcnt lgkmcnt(6)
v_mfma_f32_16x16x32_bf16 v[44:47], v[28:31], v[132:135], v[44:47]
s_waitcnt lgkmcnt(4)
v_mfma_f32_16x16x32_bf16 v[48:51], v[32:35], v[132:135], v[48:51]
s_waitcnt lgkmcnt(2)
v_mfma_f32_16x16x32_bf16 v[44:47], v[68:71], v[136:139], v[44:47]
s_waitcnt lgkmcnt(0)
v_mfma_f32_16x16x32_bf16 v[48:51], v[72:75], v[136:139], v[48:51]
s_cmp_ge_u32 s78, 82
s_cbranch_scc1 have_54
spin_55:
ds_read_b32 v4, v2 offset:0
s_waitcnt lgkmcnt(0)
v_readfirstlane_b32 s78, v4
s_nop 0
s_cmp_ge_u32 s78, 82
s_cbranch_scc1 done_56
s_sleep 1
s_add_u32 s39, s39, 1
s_cmp_lt_u32 s39, 262144
s_cbranch_scc1 spin_55
done_56:
have_54:
ds_read_b64_tr_b16 v[28:29], v12 offset:16384
ds_read_b64_tr_b16 v[30:31], v12 offset:20480
ds_read_b64_tr_b16 v[32:33], v13 offset:16384
ds_read_b64_tr_b16 v[34:35], v13 offset:20480
ds_read_b64_tr_b16 v[68:69], v12 offset:24576
ds_read_b64_tr_b16 v[70:71], v12 offset:28672
ds_read_b64_tr_b16 v[72:73], v13 offset:24576
ds_read_b64_tr_b16 v[74:75], v13 offset:28672
s_waitcnt lgkmcnt(6)
v_mfma_f32_16x16x32_bf16 v[44:47], v[28:31], v[140:143], v[44:47]
s_waitcnt lgkmcnt(4)
v_mfma_f32_16x16x32_bf16 v[48:51], v[32:35], v[140:143], v[48:51]
s_waitcnt lgkmcnt(2)
v_mfma_f32_16x16x32_bf16 v[44:47], v[68:71], v[144:147], v[44:47]
s_waitcnt lgkmcnt(0)
v_mfma_f32_16x16x32_bf16 v[48:51], v[72:75], v[144:147], v[48:51]
s_cmp_ge_u32 s78, 80
s_cbranch_scc1 have_57
spin_58:
ds_read_b32 v4, v2 offset:0
s_waitcnt lgkmcnt(0)
v_readfirstlane_b32 s78, v4
s_nop 0
s_cmp_ge_u32 s78, 80
s_cbranch_scc1 done_59
s_sleep 1
s_add_u32 s39, s39, 1
s_cmp_lt_u32 s39, 262144
s_cbranch_scc1 spin_58
done_59:
have_57:
ds_read_b64_tr_b16 v[164:165], v20 offset:0
ds_read_b64_tr_b16 v[166:167], v20 offset:16384
ds_read_b64_tr_b16 v[168:169], v21 offset:0
ds_read_b64_tr_b16 v[170:171], v21 offset:16384
ds_read_b64_tr_b16 v[172:173], v22 offset:0
ds_read_b64_tr_b16 v[174:175], v22 offset:16384
ds_read_b64_tr_b16 v[176:177], v23 offset:0
ds_read_b64_tr_b16 v[178:179], v23 offset:16384
s_waitcnt lgkmcnt(0)
ds_read_b64_tr_b16 v[180:181], v24 offset:0
ds_read_b64_tr_b16 v[182:183], v24 offset:16384
ds_read_b64_tr_b16 v[184:185], v25 offset:0
ds_read_b64_tr_b16 v[186:187], v25 offset:16384
ds_read_b64_tr_b16 v[188:189], v26 offset:0
ds_read_b64_tr_b16 v[190:191], v26 offset:16384
ds_read_b64_tr_b16 v[192:193], v27 offset:0
ds_read_b64_tr_b16 v[194:195], v27 offset:16384
s_waitcnt lgkmcnt(0)
ds_read_b64_tr_b16 v[196:197], v20 offset:32768
ds_read_b64_tr_b16 v[198:199], v20 offset:49152
ds_read_b64_tr_b16 v[200:201], v21 offset:32768
ds_read_b64_tr_b16 v[202:203], v21 offset:49152
ds_read_b64_tr_b16 v[204:205], v22 offset:32768
ds_read_b64_tr_b16 v[206:207], v22 offset:49152
ds_read_b64_tr_b16 v[208:209], v23 offset:32768
ds_read_b64_tr_b16 v[210:211], v23 offset:49152
s_waitcnt lgkmcnt(0)
ds_read_b64_tr_b16 v[212:213], v24 offset:32768
ds_read_b64_tr_b16 v[214:215], v24 offset:49152
ds_read_b64_tr_b16 v[216:217], v25 offset:32768
ds_read_b64_tr_b16 v[218:219], v25 offset:49152
ds_read_b64_tr_b16 v[220:221], v26 offset:32768
ds_read_b64_tr_b16 v[222:223], v26 offset:49152
ds_read_b64_tr_b16 v[224:225], v27 offset:32768
ds_read_b64_tr_b16 v[226:227], v27 offset:49152
s_waitcnt lgkmcnt(0)
s_cmp_ge_u32 s78, 86
s_cbranch_scc1 have_60
spin_61:
ds_read_b32 v4, v2 offset:0
s_waitcnt lgkmcnt(0)
v_readfirstlane_b32 s78, v4
s_nop 0
s_cmp_ge_u32 s78, 86
s_cbranch_scc1 done_62
s_add_u32 s39, s39, 1
s_cmp_lt_u32 s39, 262144
s_cbranch_scc1 spin_61
done_62:
have_60:
ds_read_b64_tr_b16 v[28:29], v12 offset:32768
ds_read_b64_tr_b16 v[30:31], v12 offset:36864
ds_read_b64_tr_b16 v[32:33], v13 offset:32768
ds_read_b64_tr_b16 v[34:35], v13 offset:36864
ds_read_b64_tr_b16 v[68:69], v12 offset:40960
ds_read_b64_tr_b16 v[70:71], v12 offset:45056
ds_read_b64_tr_b16 v[72:73], v13 offset:40960
ds_read_b64_tr_b16 v[74:75], v13 offset:45056
s_waitcnt lgkmcnt(6)
v_mfma_f32_16x16x32_bf16 v[44:47], v[28:31], v[148:151], v[44:47]
s_waitcnt lgkmcnt(4)
v_mfma_f32_16x16x32_bf16 v[48:51], v[32:35], v[148:151], v[48:51]
s_waitcnt lgkmcnt(2)
v_mfma_f32_16x16x32_bf16 v[44:47], v[68:71], v[152:155], v[44:47]
s_waitcnt lgkmcnt(0)
v_mfma_f32_16x16x32_bf16 v[48:51], v[72:75], v[152:155], v[48:51]
s_waitcnt vmcnt(0)
spin_63:
ds_read_b32 v4, v2 offset:280
s_waitcnt lgkmcnt(0)
v_readfirstlane_b32 s65, v4
s_nop 0
s_cmp_ge_u32 s65, 1
s_cbranch_scc1 done_64
s_add_u32 s39, s39, 1
s_cmp_lt_u32 s39, 262144
s_cbranch_scc1 spin_63
done_64:
v_lshlrev_b32 v36, 2, v0
v_add_u32 v36, 159104, v36
ds_read_b32 v228, v36
s_cmp_ge_u32 s78, 90
s_cbranch_scc1 have_65
spin_66:
ds_read_b32 v4, v2 offset:0
s_waitcnt lgkmcnt(0)
v_readfirstlane_b32 s78, v4
s_nop 0
s_cmp_ge_u32 s78, 90
s_cbranch_scc1 done_67
s_add_u32 s39, s39, 1
s_cmp_lt_u32 s39, 262144
s_cbranch_scc1 spin_66
done_67:
have_65:
ds_read_b64_tr_b16 v[28:29], v12 offset:49152
ds_read_b64_tr_b16 v[30:31], v12 offset:53248
ds_read_b64_tr_b16 v[32:33], v13 offset:49152
ds_read_b64_tr_b16 v[34:35], v13 offset:53248
ds_read_b64_tr_b16 v[68:69], v12 offset:57344
ds_read_b64_tr_b16 v[70:71], v12 offset:61440
ds_read_b64_tr_b16 v[72:73], v13 offset:57344
ds_read_b64_tr_b16 v[74:75], v13 offset:61440
s_waitcnt lgkmcnt(6)
v_mfma_f32_16x16x32_bf16 v[44:47], v[28:31], v[156:159], v[44:47]
s_waitcnt lgkmcnt(4)
v_mfma_f32_16x16x32_bf16 v[48:51], v[32:35], v[156:159], v[48:51]
s_waitcnt lgkmcnt(2)
v_mfma_f32_16x16x32_bf16 v[44:47], v[68:71], v[160:163], v[44:47]
s_waitcnt lgkmcnt(0)
v_mfma_f32_16x16x32_bf16 v[48:51], v[72:75], v[160:163], v[48:51]
s_nop 5
v_mov_b32 v36, v44
s_nop 1
v_mov_b32_dpp v36, v46 quad_perm:[0,1,2,3] row_mask:0xf bank_mask:0x2
s_nop 1
v_mov_b32_dpp v36, v48 quad_perm:[0,1,2,3] row_mask:0xf bank_mask:0x4
s_nop 1
v_mov_b32_dpp v36, v50 quad_perm:[0,1,2,3] row_mask:0xf bank_mask:0x8
v_mov_b32 v38, v45
s_nop 1
v_mov_b32_dpp v38, v47 quad_perm:[0,1,2,3] row_mask:0xf bank_mask:0x2
s_nop 1
v_mov_b32_dpp v38, v49 quad_perm:[0,1,2,3] row_mask:0xf bank_mask:0x4
s_nop 1
v_mov_b32_dpp v38, v51 quad_perm:[0,1,2,3] row_mask:0xf bank_mask:0x8
v_and_or_b32 v36, v36, s68, v9
v_mov_b32 v37, v8
v_and_or_b32 v38, v38, s68, v9
v_mov_b32 v39, v8
s_cmp_eq_u32 s65, 2
s_cbranch_scc0 slow1_68
global_store_dwordx4 v14, v[36:39], s[30:31]
poll_70:
global_load_dwordx4 v[40:43], v15, s[30:31] sc1
s_waitcnt vmcnt(0)
v_bitop3_b32 v46, v40, v42, s37 bitop3:0x7e
v_bitop3_b32 v44, v41, v43, s36 bitop3:0x7e
v_and_or_b32 v44, v46, 15, v44
v_cmp_ne_u32 vcc, 0, v44
s_nop 0
s_cmp_eq_u64 vcc, 0
s_cbranch_scc1 pdone_71
s_add_u32 s39, s39, 1
s_cmp_lt_u32 s39, 262144
s_cbranch_scc1 poll_70
pdone_71:
s_branch pub1_69
slow1_68:
global_store_dwordx4 v14, v[36:39], s[30:31] sc1
poll_72:
global_load_dwordx4 v[40:43], v15, s[30:31] sc1
s_waitcnt vmcnt(0)
v_bitop3_b32 v46, v40, v42, s37 bitop3:0x7e
v_bitop3_b32 v44, v41, v43, s36 bitop3:0x7e
v_and_or_b32 v44, v46, 15, v44
v_cmp_ne_u32 vcc, 0, v44
s_nop 0
s_cmp_eq_u64 vcc, 0
s_cbranch_scc1 pdone_73
s_add_u32 s39, s39, 1
s_cmp_lt_u32 s39, 262144
s_cbranch_scc1 poll_72
pdone_73:
pub1_69:
v_and_b32 v40, s68, v40
v_and_b32 v42, s68, v42
s_waitcnt lgkmcnt(0)
v_mul_f32 v40, v40, v228
v_mul_f32 v42, v42, v228
s_nop 1
v_permlane32_swap_b32 v40, v42
v_add_f32 v40, v40, v42
v_mov_b32 v41, v40
s_nop 1
v_permlane16_swap_b32 v40, v41
v_add_f32 v40, v40, v41
s_nop 1
v_add_f32_dpp v40, v40, v40 row_ror:8 row_mask:0xf bank_mask:0xf
v_cvt_pk_bf16_f32 v40, v40, v40
ds_write_b16 v18, v40
s_waitcnt lgkmcnt(0)
s_barrier
ds_read_b128 v[40:43], v19
ds_read_b128 v[44:47], v19 offset:64
s_waitcnt lgkmcnt(1)
v_mfma_f32_16x16x32_bf16 v[48:51], v[40:43], v[164:167], 0
v_mfma_f32_16x16x32_bf16 v[52:55], v[40:43], v[168:171], 0
v_mfma_f32_16x16x32_bf16 v[56:59], v[40:43], v[172:175], 0
v_mfma_f32_16x16x32_bf16 v[60:63], v[40:43], v[176:179], 0
v_mfma_f32_16x16x32_bf16 v[64:67], v[40:43], v[180:183], 0
v_mfma_f32_16x16x32_bf16 v[68:71], v[40:43], v[184:187], 0
v_mfma_f32_16x16x32_bf16 v[72:75], v[40:43], v[188:191], 0
v_mfma_f32_16x16x32_bf16 v[76:79], v[40:43], v[192:195], 0
s_waitcnt lgkmcnt(0)
v_mfma_f32_16x16x32_bf16 v[48:51], v[44:47], v[196:199], v[48:51]
v_mfma_f32_16x16x32_bf16 v[52:55], v[44:47], v[200:203], v[52:55]
v_mfma_f32_16x16x32_bf16 v[56:59], v[44:47], v[204:207], v[56:59]
v_mfma_f32_16x16x32_bf16 v[60:63], v[44:47], v[208:211], v[60:63]
v_mfma_f32_16x16x32_bf16 v[64:67], v[44:47], v[212:215], v[64:67]
v_mfma_f32_16x16x32_bf16 v[68:71], v[44:47], v[216:219], v[68:71]
v_mfma_f32_16x16x32_bf16 v[72:75], v[44:47], v[220:223], v[72:75]
v_mfma_f32_16x16x32_bf16 v[76:79], v[44:47], v[224:227], v[76:79]
s_nop 0
v_mov_b32 v36, v48
s_nop 1
v_mov_b32_dpp v36, v52 quad_perm:[0,1,2,3] row_mask:0x2 bank_mask:0xf
s_nop 1
v_mov_b32_dpp v36, v56 quad_perm:[0,1,2,3] row_mask:0x4 bank_mask:0xf
s_nop 1
v_mov_b32_dpp v36, v60 quad_perm:[0,1,2,3] row_mask:0x8 bank_mask:0xf
v_mov_b32 v38, v64
s_nop 1
v_mov_b32_dpp v38, v68 quad_perm:[0,1,2,3] row_mask:0x2 bank_mask:0xf
s_nop 1
v_mov_b32_dpp v38, v72 quad_perm:[0,1,2,3] row_mask:0x4 bank_mask:0xf
s_nop 1
v_mov_b32_dpp v38, v76 quad_perm:[0,1,2,3] row_mask:0x8 bank_mask:0xf
v_and_or_b32 v36, v36, s68, v9
v_and_or_b32 v38, v38, s68, v9
global_store_dwordx4 v16, v[36:39], s[30:31] sc1
s_endpgm
L_loader:
s_nop 7
s_nop 3
s_setprio 3
v_lshrrev_b32 v30, 3, v0
v_bfe_u32 v31, v0, 4, 2
v_lshlrev_b32 v31, 1, v31
v_and_b32 v32, 7, v0
v_xor_b32 v31, v31, v32
v_lshlrev_b32 v31, 4, v31
v_lshl_add_u32 v2, v30, 13, v31
v_mul_u32_u24 v3, 3584, v30
v_add_u32 v3, v3, v31
v_lshl_add_u32 v4, v30, 10, v31
s_lshr_b32 s72, s33, 3
s_lshl_b32 s72, s72, 20
s_lshl_b32 s73, s32, 10
s_add_u32 s72, s72, s73
s_and_b32 s73, s33, 7
s_lshl_b32 s73, s73, 7
s_add_u32 s72, s72, s73
s_waitcnt lgkmcnt(0)
s_add_u32 s48, s14, s72
s_addc_u32 s49, s15, 0
s_mov_b32 s50, 1040512
s_mov_b32 s51, 0x20000
s_mov_b32 m0, 131072
s_mov_b32 s76, 0
buffer_load_dwordx4 v2, s[48:51], s76 offen nt lds
s_mov_b32 m0, 132096
s_mov_b32 s76, 65536
buffer_load_dwordx4 v2, s[48:51], s76 offen nt lds
s_mov_b32 m0, 133120
s_mov_b32 s76, 131072
buffer_load_dwordx4 v2, s[48:51], s76 offen nt lds
s_mov_b32 m0, 134144
s_mov_b32 s76, 196608
buffer_load_dwordx4 v2, s[48:51], s76 offen nt lds
s_mov_b32 m0, 135168
s_mov_b32 s76, 262144
buffer_load_dwordx4 v2, s[48:51], s76 offen nt lds
s_mov_b32 m0, 136192
s_mov_b32 s76, 327680
buffer_load_dwordx4 v2, s[48:51], s76 offen nt lds
s_mov_b32 m0, 137216
s_mov_b32 s76, 393216
buffer_load_dwordx4 v2, s[48:51], s76 offen nt lds
s_mov_b32 m0, 138240
s_mov_b32 s76, 458752
buffer_load_dwordx4 v2, s[48:51], s76 offen nt lds
s_mov_b32 m0, 139264
s_mov_b32 s76, 524288
buffer_load_dwordx4 v2, s[48:51], s76 offen nt lds
s_mov_b32 m0, 140288
s_mov_b32 s76, 589824
buffer_load_dwordx4 v2, s[48:51], s76 offen nt lds
s_mov_b32 m0, 141312
s_mov_b32 s76, 655360
buffer_load_dwordx4 v2, s[48:51], s76 offen nt lds
s_mov_b32 m0, 142336
s_mov_b32 s76, 720896
buffer_load_dwordx4 v2, s[48:51], s76 offen nt lds
s_mov_b32 m0, 143360
s_mov_b32 s76, 786432
buffer_load_dwordx4 v2, s[48:51], s76 offen nt lds
s_mov_b32 m0, 144384
s_mov_b32 s76, 851968
buffer_load_dwordx4 v2, s[48:51], s76 offen nt lds
s_mov_b32 m0, 145408
s_mov_b32 s76, 917504
buffer_load_dwordx4 v2, s[48:51], s76 offen nt lds
s_mov_b32 m0, 146432
s_mov_b32 s76, 983040
buffer_load_dwordx4 v2, s[48:51], s76 offen nt lds
s_mul_i32 s72, s32, 28
s_add_u32 s72, s72, s33
s_and_b32 s73, s72, 3
s_mul_i32 s73, s73, 458752
s_lshr_b32 s74, s72, 3
s_lshl_b32 s74, s74, 7
s_add_u32 s73, s73, s74
s_bitcmp1_b32 s72, 2
s_cselect_b32 s74, s22, s20
s_cselect_b32 s75, s23, s21
s_add_u32 s52, s74, s73
s_addc_u32 s53, s75, 0
s_cmp_lt_u32 s33, 28
s_cselect_b32 s54, 455296, 0
s_mov_b32 s55, 0x20000
s_mov_b32 m0, 114688
s_mov_b32 s76, 0
buffer_load_dwordx4 v3, s[52:55], s76 offen nt lds
s_mov_b32 m0, 115712
s_mov_b32 s76, 28672
buffer_load_dwordx4 v3, s[52:55], s76 offen nt lds
s_mov_b32 m0, 116736
s_mov_b32 s76, 57344
buffer_load_dwordx4 v3, s[52:55], s76 offen nt lds
s_mov_b32 m0, 117760
s_mov_b32 s76, 86016
buffer_load_dwordx4 v3, s[52:55], s76 offen nt lds
s_mov_b32 m0, 118784
s_mov_b32 s76, 114688
buffer_load_dwordx4 v3, s[52:55], s76 offen nt lds
s_mov_b32 m0, 119808
s_mov_b32 s76, 143360
buffer_load_dwordx4 v3, s[52:55], s76 offen nt lds
s_mov_b32 m0, 120832
s_mov_b32 s76, 172032
buffer_load_dwordx4 v3, s[52:55], s76 offen nt lds
s_mov_b32 m0, 121856
s_mov_b32 s76, 200704
buffer_load_dwordx4 v3, s[52:55], s76 offen nt lds
s_barrier
s_waitcnt vmcnt(20)
v_mov_b32 v33, 159488
v_lshl_add_u32 v22, v0, 2, v33
v_mov_b32 v21, 1
ds_write_b32 v22, v21
s_mov_b32 m0, 122880
s_mov_b32 s76, 229376
buffer_load_dwordx4 v3, s[52:55], s76 offen nt lds
s_mov_b32 m0, 123904
s_mov_b32 s76, 258048
buffer_load_dwordx4 v3, s[52:55], s76 offen nt lds
s_mov_b32 m0, 124928
s_mov_b32 s76, 286720
buffer_load_dwordx4 v3, s[52:55], s76 offen nt lds
s_mov_b32 m0, 125952
s_mov_b32 s76, 315392
buffer_load_dwordx4 v3, s[52:55], s76 offen nt lds
s_waitcnt vmcnt(20)
v_mov_b32 v33, 159488
v_lshl_add_u32 v22, v0, 2, v33
v_mov_b32 v21, 2
ds_write_b32 v22, v21
s_mov_b32 m0, 126976
s_mov_b32 s76, 344064
buffer_load_dwordx4 v3, s[52:55], s76 offen nt lds
s_mov_b32 m0, 128000
s_mov_b32 s76, 372736
buffer_load_dwordx4 v3, s[52:55], s76 offen nt lds
s_mov_b32 m0, 129024
s_mov_b32 s76, 401408
buffer_load_dwordx4 v3, s[52:55], s76 offen nt lds
s_mov_b32 m0, 130048
s_mov_b32 s76, 430080
buffer_load_dwordx4 v3, s[52:55], s76 offen nt lds
s_waitcnt vmcnt(20)
v_mov_b32 v33, 159488
v_lshl_add_u32 v22, v0, 2, v33
v_mov_b32 v21, 3
ds_write_b32 v22, v21
v_lshrrev_b32 v30, 4, v0
v_and_b32 v31, 15, v0
v_lshlrev_b32 v32, 8, v30
v_add_u32 v33, 0, v30
v_xor_b32 v33, v33, v31
v_lshl_add_u32 v6, v33, 4, v32
v_add_u32 v33, 4, v30
v_xor_b32 v33, v33, v31
v_lshl_add_u32 v7, v33, 4, v32
v_add_u32 v7, 7168, v7
v_add_u32 v33, 8, v30
v_xor_b32 v33, v33, v31
v_lshl_add_u32 v8, v33, 4, v32
v_add_u32 v8, 14336, v8
v_add_u32 v33, 12, v30
v_xor_b32 v33, v33, v31
v_lshl_add_u32 v9, v33, 4, v32
v_add_u32 v9, 21504, v9
s_lshl_b32 s72, s34, 3
s_add_u32 s72, s72, s32
s_lshl_b32 s72, s72, 20
s_lshl_b32 s73, s35, 10
s_add_u32 s72, s72, s73
s_add_u32 s40, s10, s72
s_addc_u32 s41, s11, 0
s_mov_b32 s42, 0xfe400
s_mov_b32 s43, 0x20000
s_add_u32 s44, s12, s72
s_addc_u32 s45, s13, 0
s_mov_b32 s46, 0xfe400
s_mov_b32 s47, 0x20000
v_mov_b32 v20, 159488
v_lshlrev_b32 v33, 2, v0
v_add_u32 v22, 159488, v33
s_mov_b32 m0, 0
s_mov_b32 s76, 0
buffer_load_dwordx4 v6, s[40:43], s76 offen nt lds
buffer_load_dwordx4 v7, s[40:43], s76 offen offset:1024 nt lds
buffer_load_dwordx4 v8, s[40:43], s76 offen offset:2048 nt lds
buffer_load_dwordx4 v9, s[40:43], s76 offen offset:3072 nt lds
s_waitcnt vmcnt(20)
v_mov_b32 v21, 4
ds_write_b32 v22, v21
s_mov_b32 m0, 4096
s_mov_b32 s76, 32768
buffer_load_dwordx4 v6, s[40:43], s76 offen nt lds
buffer_load_dwordx4 v7, s[40:43], s76 offen offset:1024 nt lds
buffer_load_dwordx4 v8, s[40:43], s76 offen offset:2048 nt lds
buffer_load_dwordx4 v9, s[40:43], s76 offen offset:3072 nt lds
s_waitcnt vmcnt(20)
v_mov_b32 v21, 5
ds_write_b32 v22, v21
v_lshlrev_b32 v33, 1, v30
v_add_u32 v33, 0, v33
v_xor_b32 v33, v33, v31
v_lshl_add_u32 v36, v33, 4, v32
v_lshlrev_b32 v33, 1, v30
v_add_u32 v33, 8, v33
v_xor_b32 v33, v33, v31
v_lshl_add_u32 v37, v33, 4, v32
v_add_u32 v37, 7168, v37
v_lshlrev_b32 v33, 1, v30
v_add_u32 v33, 0, v33
v_xor_b32 v33, v33, v31
v_lshl_add_u32 v38, v33, 4, v32
v_add_u32 v38, 14336, v38
v_lshlrev_b32 v33, 1, v30
v_add_u32 v33, 8, v33
v_xor_b32 v33, v33, v31
v_lshl_add_u32 v39, v33, 4, v32
v_add_u32 v39, 21504, v39
v_xor_b32 v33, 0, v0
v_lshlrev_b32 v12, 4, v33
v_xor_b32 v33, 2, v0
v_lshlrev_b32 v13, 4, v33
v_xor_b32 v33, 4, v0
v_lshlrev_b32 v14, 4, v33
v_xor_b32 v33, 6, v0
v_lshlrev_b32 v15, 4, v33
v_xor_b32 v33, 8, v0
v_lshlrev_b32 v16, 4, v33
v_xor_b32 v33, 10, v0
v_lshlrev_b32 v17, 4, v33
v_xor_b32 v33, 12, v0
v_lshlrev_b32 v18, 4, v33
v_xor_b32 v33, 14, v0
v_lshlrev_b32 v19, 4, v33
s_mul_i32 s72, s33, 57344
s_lshl_b32 s73, s32, 7
s_add_u32 s72, s72, s73
s_add_u32 s56, s24, s72
s_addc_u32 s57, s25, 0
s_mov_b32 s58, 56448
s_mov_b32 s59, 0x20000
s_lshl_b32 s72, s32, 19
s_lshl_b32 s73, s35, 16
s_add_u32 s72, s72, s73
s_add_u32 s60, s16, s72
s_addc_u32 s61, s17, 0
s_mov_b32 s62, 0x10000
s_mov_b32 s63, 0x20000
s_lshl_b32 s79, s34, 14
s_mov_b32 m0, 8192
s_mov_b32 s76, 65536
buffer_load_dwordx4 v6, s[40:43], s76 offen nt lds
buffer_load_dwordx4 v7, s[40:43], s76 offen offset:1024 nt lds
buffer_load_dwordx4 v8, s[40:43], s76 offen offset:2048 nt lds
buffer_load_dwordx4 v9, s[40:43], s76 offen offset:3072 nt lds
s_waitcnt vmcnt(20)
v_mov_b32 v21, 6
ds_write_b32 v22, v21
s_mov_b32 m0, 12288
s_mov_b32 s76, 98304
buffer_load_dwordx4 v6, s[40:43], s76 offen nt lds
buffer_load_dwordx4 v7, s[40:43], s76 offen offset:1024 nt lds
buffer_load_dwordx4 v8, s[40:43], s76 offen offset:2048 nt lds
buffer_load_dwordx4 v9, s[40:43], s76 offen offset:3072 nt lds
s_waitcnt vmcnt(20)
v_mov_b32 v21, 7
ds_write_b32 v22, v21
s_mov_b32 m0, 16384
s_mov_b32 s76, 131072
buffer_load_dwordx4 v6, s[40:43], s76 offen nt lds
buffer_load_dwordx4 v7, s[40:43], s76 offen offset:1024 nt lds
buffer_load_dwordx4 v8, s[40:43], s76 offen offset:2048 nt lds
buffer_load_dwordx4 v9, s[40:43], s76 offen offset:3072 nt lds
s_waitcnt vmcnt(20)
v_mov_b32 v21, 8
ds_write_b32 v22, v21
s_mov_b32 m0, 20480
s_mov_b32 s76, 163840
buffer_load_dwordx4 v6, s[40:43], s76 offen nt lds
buffer_load_dwordx4 v7, s[40:43], s76 offen offset:1024 nt lds
buffer_load_dwordx4 v8, s[40:43], s76 offen offset:2048 nt lds
buffer_load_dwordx4 v9, s[40:43], s76 offen offset:3072 nt lds
s_waitcnt vmcnt(20)
v_mov_b32 v21, 9
ds_write_b32 v22, v21
s_mov_b32 m0, 24576
s_mov_b32 s76, 196608
buffer_load_dwordx4 v6, s[40:43], s76 offen nt lds
buffer_load_dwordx4 v7, s[40:43], s76 offen offset:1024 nt lds
buffer_load_dwordx4 v8, s[40:43], s76 offen offset:2048 nt lds
buffer_load_dwordx4 v9, s[40:43], s76 offen offset:3072 nt lds
s_waitcnt vmcnt(20)
v_mov_b32 v21, 10
ds_write_b32 v22, v21
s_mov_b32 m0, 28672
s_mov_b32 s76, 229376
buffer_load_dwordx4 v6, s[40:43], s76 offen nt lds
buffer_load_dwordx4 v7, s[40:43], s76 offen offset:1024 nt lds
buffer_load_dwordx4 v8, s[40:43], s76 offen offset:2048 nt lds
buffer_load_dwordx4 v9, s[40:43], s76 offen offset:3072 nt lds
s_waitcnt vmcnt(20)
v_mov_b32 v21, 11
ds_write_b32 v22, v21
spin_74:
ds_read_b32 v24, v20 offset:260
s_waitcnt lgkmcnt(0)
v_readfirstlane_b32 s77, v24
s_nop 0
s_cmp_ge_u32 s77, 1
s_cbranch_scc1 done_75
s_sleep 1
s_add_u32 s39, s39, 1
s_cmp_lt_u32 s39, 262144
s_cbranch_scc1 spin_74
done_75:
s_mov_b32 m0, 131072
s_mov_b32 s76, 0
buffer_load_dwordx4 v4, s[56:59], s76 offen nt lds
s_mov_b32 m0, 132096
s_mov_b32 s76, 8192
buffer_load_dwordx4 v4, s[56:59], s76 offen nt lds
s_mov_b32 m0, 133120
s_mov_b32 s76, 16384
buffer_load_dwordx4 v4, s[56:59], s76 offen nt lds
s_mov_b32 m0, 134144
s_mov_b32 s76, 24576
buffer_load_dwordx4 v4, s[56:59], s76 offen nt lds
s_waitcnt vmcnt(20)
v_mov_b32 v21, 12
ds_write_b32 v22, v21
s_mov_b32 m0, 135168
s_mov_b32 s76, 32768
buffer_load_dwordx4 v4, s[56:59], s76 offen nt lds
s_mov_b32 m0, 136192
s_mov_b32 s76, 40960
buffer_load_dwordx4 v4, s[56:59], s76 offen nt lds
s_mov_b32 m0, 137216
s_mov_b32 s76, 49152
buffer_load_dwordx4 v4, s[56:59], s76 offen nt lds
s_mov_b32 s58, 0
s_mov_b32 m0, 138240
s_mov_b32 s76, 0
buffer_load_dwordx4 v4, s[56:59], s76 offen nt lds
s_waitcnt vmcnt(20)
v_mov_b32 v21, 13
ds_write_b32 v22, v21
s_mov_b32 m0, 32768
s_mov_b32 s76, 262144
buffer_load_dwordx4 v6, s[40:43], s76 offen nt lds
buffer_load_dwordx4 v7, s[40:43], s76 offen offset:1024 nt lds
buffer_load_dwordx4 v8, s[40:43], s76 offen offset:2048 nt lds
buffer_load_dwordx4 v9, s[40:43], s76 offen offset:3072 nt lds
s_waitcnt vmcnt(20)
v_mov_b32 v21, 14
ds_write_b32 v22, v21
s_mov_b32 m0, 36864
s_mov_b32 s76, 294912
buffer_load_dwordx4 v6, s[40:43], s76 offen nt lds
buffer_load_dwordx4 v7, s[40:43], s76 offen offset:1024 nt lds
buffer_load_dwordx4 v8, s[40:43], s76 offen offset:2048 nt lds
buffer_load_dwordx4 v9, s[40:43], s76 offen offset:3072 nt lds
s_waitcnt vmcnt(20)
v_mov_b32 v21, 15
ds_write_b32 v22, v21
s_mov_b32 m0, 40960
s_mov_b32 s76, 327680
buffer_load_dwordx4 v6, s[40:43], s76 offen nt lds
buffer_load_dwordx4 v7, s[40:43], s76 offen offset:1024 nt lds
buffer_load_dwordx4 v8, s[40:43], s76 offen offset:2048 nt lds
buffer_load_dwordx4 v9, s[40:43], s76 offen offset:3072 nt lds
s_waitcnt vmcnt(20)
v_mov_b32 v21, 16
ds_write_b32 v22, v21
s_mov_b32 m0, 45056
s_mov_b32 s76, 360448
buffer_load_dwordx4 v6, s[40:43], s76 offen nt lds
buffer_load_dwordx4 v7, s[40:43], s76 offen offset:1024 nt lds
buffer_load_dwordx4 v8, s[40:43], s76 offen offset:2048 nt lds
buffer_load_dwordx4 v9, s[40:43], s76 offen offset:3072 nt lds
s_waitcnt vmcnt(20)
v_mov_b32 v21, 17
ds_write_b32 v22, v21
s_mov_b32 m0, 49152
s_mov_b32 s76, 393216
buffer_load_dwordx4 v6, s[40:43], s76 offen nt lds
buffer_load_dwordx4 v7, s[40:43], s76 offen offset:1024 nt lds
buffer_load_dwordx4 v8, s[40:43], s76 offen offset:2048 nt lds
buffer_load_dwordx4 v9, s[40:43], s76 offen offset:3072 nt lds
s_waitcnt vmcnt(20)
v_mov_b32 v21, 18
ds_write_b32 v22, v21
s_mov_b32 m0, 53248
s_mov_b32 s76, 425984
buffer_load_dwordx4 v6, s[40:43], s76 offen nt lds
buffer_load_dwordx4 v7, s[40:43], s76 offen offset:1024 nt lds
buffer_load_dwordx4 v8, s[40:43], s76 offen offset:2048 nt lds
buffer_load_dwordx4 v9, s[40:43], s76 offen offset:3072 nt lds
s_waitcnt vmcnt(20)
v_mov_b32 v21, 19
ds_write_b32 v22, v21
s_mov_b32 m0, 57344
s_mov_b32 s76, 458752
buffer_load_dwordx4 v6, s[40:43], s76 offen nt lds
buffer_load_dwordx4 v7, s[40:43], s76 offen offset:1024 nt lds
buffer_load_dwordx4 v8, s[40:43], s76 offen offset:2048 nt lds
buffer_load_dwordx4 v9, s[40:43], s76 offen offset:3072 nt lds
s_waitcnt vmcnt(20)
v_mov_b32 v21, 20
ds_write_b32 v22, v21
s_mov_b32 m0, 61440
s_mov_b32 s76, 491520
buffer_load_dwordx4 v6, s[40:43], s76 offen nt lds
buffer_load_dwordx4 v7, s[40:43], s76 offen offset:1024 nt lds
buffer_load_dwordx4 v8, s[40:43], s76 offen offset:2048 nt lds
buffer_load_dwordx4 v9, s[40:43], s76 offen offset:3072 nt lds
s_waitcnt vmcnt(20)
v_mov_b32 v21, 21
ds_write_b32 v22, v21
s_mov_b32 m0, 65536
s_mov_b32 s76, 524288
buffer_load_dwordx4 v6, s[40:43], s76 offen nt lds
buffer_load_dwordx4 v7, s[40:43], s76 offen offset:1024 nt lds
buffer_load_dwordx4 v8, s[40:43], s76 offen offset:2048 nt lds
buffer_load_dwordx4 v9, s[40:43], s76 offen offset:3072 nt lds
s_waitcnt vmcnt(20)
v_mov_b32 v21, 22
ds_write_b32 v22, v21
s_mov_b32 m0, 69632
s_mov_b32 s76, 557056
buffer_load_dwordx4 v6, s[40:43], s76 offen nt lds
buffer_load_dwordx4 v7, s[40:43], s76 offen offset:1024 nt lds
buffer_load_dwordx4 v8, s[40:43], s76 offen offset:2048 nt lds
buffer_load_dwordx4 v9, s[40:43], s76 offen offset:3072 nt lds
s_waitcnt vmcnt(20)
v_mov_b32 v21, 23
ds_write_b32 v22, v21
s_mov_b32 m0, 73728
s_mov_b32 s76, 589824
buffer_load_dwordx4 v6, s[40:43], s76 offen nt lds
buffer_load_dwordx4 v7, s[40:43], s76 offen offset:1024 nt lds
buffer_load_dwordx4 v8, s[40:43], s76 offen offset:2048 nt lds
buffer_load_dwordx4 v9, s[40:43], s76 offen offset:3072 nt lds
s_waitcnt vmcnt(20)
v_mov_b32 v21, 24
ds_write_b32 v22, v21
s_mov_b32 m0, 77824
s_mov_b32 s76, 622592
buffer_load_dwordx4 v6, s[40:43], s76 offen nt lds
buffer_load_dwordx4 v7, s[40:43], s76 offen offset:1024 nt lds
buffer_load_dwordx4 v8, s[40:43], s76 offen offset:2048 nt lds
buffer_load_dwordx4 v9, s[40:43], s76 offen offset:3072 nt lds
s_waitcnt vmcnt(20)
v_mov_b32 v21, 25
ds_write_b32 v22, v21
s_mov_b32 m0, 81920
s_mov_b32 s76, 655360
buffer_load_dwordx4 v6, s[40:43], s76 offen nt lds
buffer_load_dwordx4 v7, s[40:43], s76 offen offset:1024 nt lds
buffer_load_dwordx4 v8, s[40:43], s76 offen offset:2048 nt lds
buffer_load_dwordx4 v9, s[40:43], s76 offen offset:3072 nt lds
s_waitcnt vmcnt(20)
v_mov_b32 v21, 26
ds_write_b32 v22, v21
s_mov_b32 m0, 86016
s_mov_b32 s76, 688128
buffer_load_dwordx4 v6, s[40:43], s76 offen nt lds
buffer_load_dwordx4 v7, s[40:43], s76 offen offset:1024 nt lds
buffer_load_dwordx4 v8, s[40:43], s76 offen offset:2048 nt lds
buffer_load_dwordx4 v9, s[40:43], s76 offen offset:3072 nt lds
s_waitcnt vmcnt(20)
v_mov_b32 v21, 27
ds_write_b32 v22, v21
s_mov_b32 m0, 90112
s_mov_b32 s76, 720896
buffer_load_dwordx4 v6, s[40:43], s76 offen nt lds
buffer_load_dwordx4 v7, s[40:43], s76 offen offset:1024 nt lds
buffer_load_dwordx4 v8, s[40:43], s76 offen offset:2048 nt lds
buffer_load_dwordx4 v9, s[40:43], s76 offen offset:3072 nt lds
s_waitcnt vmcnt(20)
v_mov_b32 v21, 28
ds_write_b32 v22, v21
s_mov_b32 m0, 94208
s_mov_b32 s76, 753664
buffer_load_dwordx4 v6, s[40:43], s76 offen nt lds
buffer_load_dwordx4 v7, s[40:43], s76 offen offset:1024 nt lds
buffer_load_dwordx4 v8, s[40:43], s76 offen offset:2048 nt lds
buffer_load_dwordx4 v9, s[40:43], s76 offen offset:3072 nt lds
s_waitcnt vmcnt(20)
v_mov_b32 v21, 29
ds_write_b32 v22, v21
s_mov_b32 m0, 98304
s_mov_b32 s76, 786432
buffer_load_dwordx4 v6, s[40:43], s76 offen nt lds
buffer_load_dwordx4 v7, s[40:43], s76 offen offset:1024 nt lds
buffer_load_dwordx4 v8, s[40:43], s76 offen offset:2048 nt lds
buffer_load_dwordx4 v9, s[40:43], s76 offen offset:3072 nt lds
s_waitcnt vmcnt(20)
v_mov_b32 v21, 30
ds_write_b32 v22, v21
s_mov_b32 m0, 102400
s_mov_b32 s76, 819200
buffer_load_dwordx4 v6, s[40:43], s76 offen nt lds
buffer_load_dwordx4 v7, s[40:43], s76 offen offset:1024 nt lds
buffer_load_dwordx4 v8, s[40:43], s76 offen offset:2048 nt lds
buffer_load_dwordx4 v9, s[40:43], s76 offen offset:3072 nt lds
s_waitcnt vmcnt(20)
v_mov_b32 v21, 31
ds_write_b32 v22, v21
s_mov_b32 m0, 106496
s_mov_b32 s76, 851968
buffer_load_dwordx4 v6, s[40:43], s76 offen nt lds
buffer_load_dwordx4 v7, s[40:43], s76 offen offset:1024 nt lds
buffer_load_dwordx4 v8, s[40:43], s76 offen offset:2048 nt lds
buffer_load_dwordx4 v9, s[40:43], s76 offen offset:3072 nt lds
s_waitcnt vmcnt(20)
v_mov_b32 v21, 32
ds_write_b32 v22, v21
s_mov_b32 m0, 110592
s_mov_b32 s76, 884736
buffer_load_dwordx4 v6, s[40:43], s76 offen nt lds
buffer_load_dwordx4 v7, s[40:43], s76 offen offset:1024 nt lds
buffer_load_dwordx4 v8, s[40:43], s76 offen offset:2048 nt lds
buffer_load_dwordx4 v9, s[40:43], s76 offen offset:3072 nt lds
s_waitcnt vmcnt(20)
v_mov_b32 v21, 33
ds_write_b32 v22, v21
spin_76:
ds_read_b32 v24, v20 offset:264
s_waitcnt lgkmcnt(0)
v_readfirstlane_b32 s77, v24
s_nop 0
s_cmp_ge_u32 s77, 1
s_cbranch_scc1 done_77
s_sleep 1
s_add_u32 s39, s39, 1
s_cmp_lt_u32 s39, 262144
s_cbranch_scc1 spin_76
done_77:
s_mov_b32 m0, 114688
s_mov_b32 s76, 917504
buffer_load_dwordx4 v6, s[40:43], s76 offen nt lds
buffer_load_dwordx4 v7, s[40:43], s76 offen offset:1024 nt lds
buffer_load_dwordx4 v8, s[40:43], s76 offen offset:2048 nt lds
buffer_load_dwordx4 v9, s[40:43], s76 offen offset:3072 nt lds
s_waitcnt vmcnt(20)
v_mov_b32 v21, 34
ds_write_b32 v22, v21
s_mov_b32 m0, 118784
s_mov_b32 s76, 950272
buffer_load_dwordx4 v6, s[40:43], s76 offen nt lds
buffer_load_dwordx4 v7, s[40:43], s76 offen offset:1024 nt lds
buffer_load_dwordx4 v8, s[40:43], s76 offen offset:2048 nt lds
buffer_load_dwordx4 v9, s[40:43], s76 offen offset:3072 nt lds
s_waitcnt vmcnt(20)
v_mov_b32 v21, 35
ds_write_b32 v22, v21
s_mov_b32 m0, 122880
s_mov_b32 s76, 983040
buffer_load_dwordx4 v6, s[40:43], s76 offen nt lds
buffer_load_dwordx4 v7, s[40:43], s76 offen offset:1024 nt lds
buffer_load_dwordx4 v8, s[40:43], s76 offen offset:2048 nt lds
buffer_load_dwordx4 v9, s[40:43], s76 offen offset:3072 nt lds
s_waitcnt vmcnt(20)
v_mov_b32 v21, 36
ds_write_b32 v22, v21
s_mov_b32 m0, 126976
s_mov_b32 s76, 1015808
buffer_load_dwordx4 v6, s[40:43], s76 offen nt lds
buffer_load_dwordx4 v7, s[40:43], s76 offen offset:1024 nt lds
buffer_load_dwordx4 v8, s[40:43], s76 offen offset:2048 nt lds
buffer_load_dwordx4 v9, s[40:43], s76 offen offset:3072 nt lds
s_waitcnt vmcnt(20)
v_mov_b32 v21, 37
ds_write_b32 v22, v21
spin_78:
ds_read_b32 v24, v20 offset:288
s_waitcnt lgkmcnt(0)
v_readfirstlane_b32 s77, v24
s_nop 0
s_cmp_ge_u32 s77, 1
s_cbranch_scc1 done_79
s_sleep 1
s_add_u32 s39, s39, 1
s_cmp_lt_u32 s39, 262144
s_cbranch_scc1 spin_78
done_79:
s_mov_b32 m0, 0
s_mov_b32 s76, 0
buffer_load_dwordx4 v36, s[44:47], s76 offen nt lds
buffer_load_dwordx4 v37, s[44:47], s76 offen offset:1024 nt lds
buffer_load_dwordx4 v38, s[44:47], s76 offen offset:2048 nt lds
buffer_load_dwordx4 v39, s[44:47], s76 offen offset:3072 nt lds
s_mov_b32 m0, 4096
s_mov_b32 s76, 32768
buffer_load_dwordx4 v36, s[44:47], s76 offen nt lds
buffer_load_dwordx4 v37, s[44:47], s76 offen offset:1024 nt lds
buffer_load_dwordx4 v38, s[44:47], s76 offen offset:2048 nt lds
buffer_load_dwordx4 v39, s[44:47], s76 offen offset:3072 nt lds
spin_80:
ds_read_b32 v24, v20 offset:292
s_waitcnt lgkmcnt(0)
v_readfirstlane_b32 s77, v24
s_nop 0
s_cmp_ge_u32 s77, 1
s_cbranch_scc1 done_81
s_sleep 1
s_add_u32 s39, s39, 1
s_cmp_lt_u32 s39, 262144
s_cbranch_scc1 spin_80
done_81:
s_mov_b32 m0, 8192
s_mov_b32 s76, 65536
buffer_load_dwordx4 v36, s[44:47], s76 offen nt lds
buffer_load_dwordx4 v37, s[44:47], s76 offen offset:1024 nt lds
buffer_load_dwordx4 v38, s[44:47], s76 offen offset:2048 nt lds
buffer_load_dwordx4 v39, s[44:47], s76 offen offset:3072 nt lds
s_mov_b32 m0, 12288
s_mov_b32 s76, 98304
buffer_load_dwordx4 v36, s[44:47], s76 offen nt lds
buffer_load_dwordx4 v37, s[44:47], s76 offen offset:1024 nt lds
buffer_load_dwordx4 v38, s[44:47], s76 offen offset:2048 nt lds
buffer_load_dwordx4 v39, s[44:47], s76 offen offset:3072 nt lds
spin_82:
ds_read_b32 v24, v20 offset:296
s_waitcnt lgkmcnt(0)
v_readfirstlane_b32 s77, v24
s_nop 0
s_cmp_ge_u32 s77, 1
s_cbranch_scc1 done_83
s_sleep 1
s_add_u32 s39, s39, 1
s_cmp_lt_u32 s39, 262144
s_cbranch_scc1 spin_82
done_83:
s_mov_b32 m0, 16384
s_mov_b32 s76, 131072
buffer_load_dwordx4 v36, s[44:47], s76 offen nt lds
buffer_load_dwordx4 v37, s[44:47], s76 offen offset:1024 nt lds
buffer_load_dwordx4 v38, s[44:47], s76 offen offset:2048 nt lds
buffer_load_dwordx4 v39, s[44:47], s76 offen offset:3072 nt lds
s_waitcnt vmcnt(36)
v_mov_b32 v21, 38
ds_write_b32 v22, v21
s_mov_b32 m0, 20480
s_mov_b32 s76, 163840
buffer_load_dwordx4 v36, s[44:47], s76 offen nt lds
buffer_load_dwordx4 v37, s[44:47], s76 offen offset:1024 nt lds
buffer_load_dwordx4 v38, s[44:47], s76 offen offset:2048 nt lds
buffer_load_dwordx4 v39, s[44:47], s76 offen offset:3072 nt lds
s_waitcnt vmcnt(36)
v_mov_b32 v21, 39
ds_write_b32 v22, v21
spin_84:
ds_read_b32 v24, v20 offset:300
s_waitcnt lgkmcnt(0)
v_readfirstlane_b32 s77, v24
s_nop 0
s_cmp_ge_u32 s77, 1
s_cbranch_scc1 done_85
s_sleep 1
s_add_u32 s39, s39, 1
s_cmp_lt_u32 s39, 262144
s_cbranch_scc1 spin_84
done_85:
s_mov_b32 m0, 24576
s_mov_b32 s76, 196608
buffer_load_dwordx4 v36, s[44:47], s76 offen nt lds
buffer_load_dwordx4 v37, s[44:47], s76 offen offset:1024 nt lds
buffer_load_dwordx4 v38, s[44:47], s76 offen offset:2048 nt lds
buffer_load_dwordx4 v39, s[44:47], s76 offen offset:3072 nt lds
s_waitcnt vmcnt(36)
v_mov_b32 v21, 40
ds_write_b32 v22, v21
s_mov_b32 m0, 28672
s_mov_b32 s76, 229376
buffer_load_dwordx4 v36, s[44:47], s76 offen nt lds
buffer_load_dwordx4 v37, s[44:47], s76 offen offset:1024 nt lds
buffer_load_dwordx4 v38, s[44:47], s76 offen offset:2048 nt lds
buffer_load_dwordx4 v39, s[44:47], s76 offen offset:3072 nt lds
s_waitcnt vmcnt(36)
v_mov_b32 v21, 41
ds_write_b32 v22, v21
s_waitcnt vmcnt(32)
v_mov_b32 v21, 42
ds_write_b32 v22, v21
spin_86:
ds_read_b128 v[24:27], v20 offset:288
s_waitcnt lgkmcnt(0)
v_min_u32 v24, v24, v25
v_min3_u32 v24, v24, v26, v27
s_nop 0
v_readfirstlane_b32 s77, v24
s_nop 0
s_cmp_ge_u32 s77, 4
s_cbranch_scc1 done_87
s_sleep 1
s_add_u32 s39, s39, 1
s_cmp_lt_u32 s39, 262144
s_cbranch_scc1 spin_86
done_87:
s_add_u32 s76, s79, 0
s_and_b32 s76, s76, 0xffff
s_add_u32 m0, s76, 65536
s_nop 0
buffer_load_dwordx4 v12, s[60:63], s76 offen lds
buffer_load_dwordx4 v13, s[60:63], s76 offen offset:1024 lds
buffer_load_dwordx4 v14, s[60:63], s76 offen offset:2048 lds
buffer_load_dwordx4 v15, s[60:63], s76 offen offset:3072 lds
s_add_u32 s76, s79, 4096
s_and_b32 s76, s76, 0xffff
s_add_u32 m0, s76, 65536
s_nop 0
buffer_load_dwordx4 v16, s[60:63], s76 offen lds
buffer_load_dwordx4 v17, s[60:63], s76 offen offset:1024 lds
buffer_load_dwordx4 v18, s[60:63], s76 offen offset:2048 lds
buffer_load_dwordx4 v19, s[60:63], s76 offen offset:3072 lds
s_waitcnt vmcnt(36)
v_mov_b32 v21, 43
ds_write_b32 v22, v21
spin_88:
ds_read_b32 v24, v20 offset:288
s_waitcnt lgkmcnt(0)
v_readfirstlane_b32 s77, v24
s_nop 0
s_cmp_ge_u32 s77, 2
s_cbranch_scc1 done_89
s_sleep 1
s_add_u32 s39, s39, 1
s_cmp_lt_u32 s39, 262144
s_cbranch_scc1 spin_88
done_89:
s_mov_b32 m0, 32768
s_mov_b32 s76, 262144
buffer_load_dwordx4 v36, s[44:47], s76 offen nt lds
buffer_load_dwordx4 v37, s[44:47], s76 offen offset:1024 nt lds
buffer_load_dwordx4 v38, s[44:47], s76 offen offset:2048 nt lds
buffer_load_dwordx4 v39, s[44:47], s76 offen offset:3072 nt lds
s_waitcnt vmcnt(36)
v_mov_b32 v21, 44
ds_write_b32 v22, v21
s_mov_b32 m0, 36864
s_mov_b32 s76, 294912
buffer_load_dwordx4 v36, s[44:47], s76 offen nt lds
buffer_load_dwordx4 v37, s[44:47], s76 offen offset:1024 nt lds
buffer_load_dwordx4 v38, s[44:47], s76 offen offset:2048 nt lds
buffer_load_dwordx4 v39, s[44:47], s76 offen offset:3072 nt lds
s_waitcnt vmcnt(36)
v_mov_b32 v21, 45
ds_write_b32 v22, v21
s_add_u32 s76, s79, 8192
s_and_b32 s76, s76, 0xffff
s_add_u32 m0, s76, 65536
s_nop 0
buffer_load_dwordx4 v12, s[60:63], s76 offen lds
buffer_load_dwordx4 v13, s[60:63], s76 offen offset:1024 lds
buffer_load_dwordx4 v14, s[60:63], s76 offen offset:2048 lds
buffer_load_dwordx4 v15, s[60:63], s76 offen offset:3072 lds
s_waitcnt vmcnt(36)
v_mov_b32 v21, 46
ds_write_b32 v22, v21
s_add_u32 s76, s79, 12288
s_and_b32 s76, s76, 0xffff
s_add_u32 m0, s76, 65536
s_nop 0
buffer_load_dwordx4 v16, s[60:63], s76 offen lds
buffer_load_dwordx4 v17, s[60:63], s76 offen offset:1024 lds
buffer_load_dwordx4 v18, s[60:63], s76 offen offset:2048 lds
buffer_load_dwordx4 v19, s[60:63], s76 offen offset:3072 lds
s_waitcnt vmcnt(36)
v_mov_b32 v21, 47
ds_write_b32 v22, v21
spin_90:
ds_read_b32 v24, v20 offset:292
s_waitcnt lgkmcnt(0)
v_readfirstlane_b32 s77, v24
s_nop 0
s_cmp_ge_u32 s77, 2
s_cbranch_scc1 done_91
s_sleep 1
s_add_u32 s39, s39, 1
s_cmp_lt_u32 s39, 262144
s_cbranch_scc1 spin_90
done_91:
s_mov_b32 m0, 40960
s_mov_b32 s76, 327680
buffer_load_dwordx4 v36, s[44:47], s76 offen nt lds
buffer_load_dwordx4 v37, s[44:47], s76 offen offset:1024 nt lds
buffer_load_dwordx4 v38, s[44:47], s76 offen offset:2048 nt lds
buffer_load_dwordx4 v39, s[44:47], s76 offen offset:3072 nt lds
s_waitcnt vmcnt(36)
v_mov_b32 v21, 48
ds_write_b32 v22, v21
s_mov_b32 m0, 45056
s_mov_b32 s76, 360448
buffer_load_dwordx4 v36, s[44:47], s76 offen nt lds
buffer_load_dwordx4 v37, s[44:47], s76 offen offset:1024 nt lds
buffer_load_dwordx4 v38, s[44:47], s76 offen offset:2048 nt lds
buffer_load_dwordx4 v39, s[44:47], s76 offen offset:3072 nt lds
s_waitcnt vmcnt(36)
v_mov_b32 v21, 49
ds_write_b32 v22, v21
s_add_u32 s76, s79, 16384
s_and_b32 s76, s76, 0xffff
s_add_u32 m0, s76, 65536
s_nop 0
buffer_load_dwordx4 v12, s[60:63], s76 offen lds
buffer_load_dwordx4 v13, s[60:63], s76 offen offset:1024 lds
buffer_load_dwordx4 v14, s[60:63], s76 offen offset:2048 lds
buffer_load_dwordx4 v15, s[60:63], s76 offen offset:3072 lds
s_waitcnt vmcnt(36)
v_mov_b32 v21, 50
ds_write_b32 v22, v21
s_add_u32 s76, s79, 20480
s_and_b32 s76, s76, 0xffff
s_add_u32 m0, s76, 65536
s_nop 0
buffer_load_dwordx4 v16, s[60:63], s76 offen lds
buffer_load_dwordx4 v17, s[60:63], s76 offen offset:1024 lds
buffer_load_dwordx4 v18, s[60:63], s76 offen offset:2048 lds
buffer_load_dwordx4 v19, s[60:63], s76 offen offset:3072 lds
s_waitcnt vmcnt(36)
v_mov_b32 v21, 51
ds_write_b32 v22, v21
spin_92:
ds_read_b32 v24, v20 offset:296
s_waitcnt lgkmcnt(0)
v_readfirstlane_b32 s77, v24
s_nop 0
s_cmp_ge_u32 s77, 2
s_cbranch_scc1 done_93
s_sleep 1
s_add_u32 s39, s39, 1
s_cmp_lt_u32 s39, 262144
s_cbranch_scc1 spin_92
done_93:
s_mov_b32 m0, 49152
s_mov_b32 s76, 393216
buffer_load_dwordx4 v36, s[44:47], s76 offen nt lds
buffer_load_dwordx4 v37, s[44:47], s76 offen offset:1024 nt lds
buffer_load_dwordx4 v38, s[44:47], s76 offen offset:2048 nt lds
buffer_load_dwordx4 v39, s[44:47], s76 offen offset:3072 nt lds
s_waitcnt vmcnt(36)
v_mov_b32 v21, 52
ds_write_b32 v22, v21
s_mov_b32 m0, 53248
s_mov_b32 s76, 425984
buffer_load_dwordx4 v36, s[44:47], s76 offen nt lds
buffer_load_dwordx4 v37, s[44:47], s76 offen offset:1024 nt lds
buffer_load_dwordx4 v38, s[44:47], s76 offen offset:2048 nt lds
buffer_load_dwordx4 v39, s[44:47], s76 offen offset:3072 nt lds
s_waitcnt vmcnt(36)
v_mov_b32 v21, 53
ds_write_b32 v22, v21
s_add_u32 s76, s79, 24576
s_and_b32 s76, s76, 0xffff
s_add_u32 m0, s76, 65536
s_nop 0
buffer_load_dwordx4 v12, s[60:63], s76 offen lds
buffer_load_dwordx4 v13, s[60:63], s76 offen offset:1024 lds
buffer_load_dwordx4 v14, s[60:63], s76 offen offset:2048 lds
buffer_load_dwordx4 v15, s[60:63], s76 offen offset:3072 lds
s_waitcnt vmcnt(36)
v_mov_b32 v21, 54
ds_write_b32 v22, v21
s_add_u32 s76, s79, 28672
s_and_b32 s76, s76, 0xffff
s_add_u32 m0, s76, 65536
s_nop 0
buffer_load_dwordx4 v16, s[60:63], s76 offen lds
buffer_load_dwordx4 v17, s[60:63], s76 offen offset:1024 lds
buffer_load_dwordx4 v18, s[60:63], s76 offen offset:2048 lds
buffer_load_dwordx4 v19, s[60:63], s76 offen offset:3072 lds
s_waitcnt vmcnt(36)
v_mov_b32 v21, 55
ds_write_b32 v22, v21
spin_94:
ds_read_b32 v24, v20 offset:300
s_waitcnt lgkmcnt(0)
v_readfirstlane_b32 s77, v24
s_nop 0
s_cmp_ge_u32 s77, 2
s_cbranch_scc1 done_95
s_sleep 1
s_add_u32 s39, s39, 1
s_cmp_lt_u32 s39, 262144
s_cbranch_scc1 spin_94
done_95:
s_mov_b32 m0, 57344
s_mov_b32 s76, 458752
buffer_load_dwordx4 v36, s[44:47], s76 offen nt lds
buffer_load_dwordx4 v37, s[44:47], s76 offen offset:1024 nt lds
buffer_load_dwordx4 v38, s[44:47], s76 offen offset:2048 nt lds
buffer_load_dwordx4 v39, s[44:47], s76 offen offset:3072 nt lds
s_waitcnt vmcnt(36)
v_mov_b32 v21, 56
ds_write_b32 v22, v21
s_mov_b32 m0, 61440
s_mov_b32 s76, 491520
buffer_load_dwordx4 v36, s[44:47], s76 offen nt lds
buffer_load_dwordx4 v37, s[44:47], s76 offen offset:1024 nt lds
buffer_load_dwordx4 v38, s[44:47], s76 offen offset:2048 nt lds
buffer_load_dwordx4 v39, s[44:47], s76 offen offset:3072 nt lds
s_waitcnt vmcnt(36)
v_mov_b32 v21, 57
ds_write_b32 v22, v21
s_add_u32 s76, s79, 32768
s_and_b32 s76, s76, 0xffff
s_add_u32 m0, s76, 65536
s_nop 0
buffer_load_dwordx4 v12, s[60:63], s76 offen lds
buffer_load_dwordx4 v13, s[60:63], s76 offen offset:1024 lds
buffer_load_dwordx4 v14, s[60:63], s76 offen offset:2048 lds
buffer_load_dwordx4 v15, s[60:63], s76 offen offset:3072 lds
s_waitcnt vmcnt(36)
v_mov_b32 v21, 58
ds_write_b32 v22, v21
s_add_u32 s76, s79, 36864
s_and_b32 s76, s76, 0xffff
s_add_u32 m0, s76, 65536
s_nop 0
buffer_load_dwordx4 v16, s[60:63], s76 offen lds
buffer_load_dwordx4 v17, s[60:63], s76 offen offset:1024 lds
buffer_load_dwordx4 v18, s[60:63], s76 offen offset:2048 lds
buffer_load_dwordx4 v19, s[60:63], s76 offen offset:3072 lds
s_waitcnt vmcnt(36)
v_mov_b32 v21, 59
ds_write_b32 v22, v21
spin_96:
ds_read_b128 v[24:27], v20 offset:304
s_waitcnt lgkmcnt(0)
v_min_u32 v24, v24, v25
v_min3_u32 v24, v24, v26, v27
s_nop 0
v_readfirstlane_b32 s77, v24
s_nop 0
s_cmp_ge_u32 s77, 1
s_cbranch_scc1 done_97
s_sleep 1
s_add_u32 s39, s39, 1
s_cmp_lt_u32 s39, 262144
s_cbranch_scc1 spin_96
done_97:
s_mov_b32 m0, 0
s_mov_b32 s76, 524288
buffer_load_dwordx4 v36, s[44:47], s76 offen nt lds
buffer_load_dwordx4 v37, s[44:47], s76 offen offset:1024 nt lds
buffer_load_dwordx4 v38, s[44:47], s76 offen offset:2048 nt lds
buffer_load_dwordx4 v39, s[44:47], s76 offen offset:3072 nt lds
s_waitcnt vmcnt(36)
v_mov_b32 v21, 60
ds_write_b32 v22, v21
s_mov_b32 m0, 4096
s_mov_b32 s76, 557056
buffer_load_dwordx4 v36, s[44:47], s76 offen nt lds
buffer_load_dwordx4 v37, s[44:47], s76 offen offset:1024 nt lds
buffer_load_dwordx4 v38, s[44:47], s76 offen offset:2048 nt lds
buffer_load_dwordx4 v39, s[44:47], s76 offen offset:3072 nt lds
s_waitcnt vmcnt(36)
v_mov_b32 v21, 61
ds_write_b32 v22, v21
s_add_u32 s76, s79, 40960
s_and_b32 s76, s76, 0xffff
s_add_u32 m0, s76, 65536
s_nop 0
buffer_load_dwordx4 v12, s[60:63], s76 offen lds
buffer_load_dwordx4 v13, s[60:63], s76 offen offset:1024 lds
buffer_load_dwordx4 v14, s[60:63], s76 offen offset:2048 lds
buffer_load_dwordx4 v15, s[60:63], s76 offen offset:3072 lds
s_waitcnt vmcnt(36)
v_mov_b32 v21, 62
ds_write_b32 v22, v21
s_add_u32 s76, s79, 45056
s_and_b32 s76, s76, 0xffff
s_add_u32 m0, s76, 65536
s_nop 0
buffer_load_dwordx4 v16, s[60:63], s76 offen lds
buffer_load_dwordx4 v17, s[60:63], s76 offen offset:1024 lds
buffer_load_dwordx4 v18, s[60:63], s76 offen offset:2048 lds
buffer_load_dwordx4 v19, s[60:63], s76 offen offset:3072 lds
s_waitcnt vmcnt(36)
v_mov_b32 v21, 63
ds_write_b32 v22, v21
spin_98:
ds_read_b128 v[24:27], v20 offset:304
s_waitcnt lgkmcnt(0)
v_min_u32 v24, v24, v25
v_min3_u32 v24, v24, v26, v27
s_nop 0
v_readfirstlane_b32 s77, v24
s_nop 0
s_cmp_ge_u32 s77, 2
s_cbranch_scc1 done_99
s_sleep 1
s_add_u32 s39, s39, 1
s_cmp_lt_u32 s39, 262144
s_cbranch_scc1 spin_98
done_99:
s_mov_b32 m0, 8192
s_mov_b32 s76, 589824
buffer_load_dwordx4 v36, s[44:47], s76 offen nt lds
buffer_load_dwordx4 v37, s[44:47], s76 offen offset:1024 nt lds
buffer_load_dwordx4 v38, s[44:47], s76 offen offset:2048 nt lds
buffer_load_dwordx4 v39, s[44:47], s76 offen offset:3072 nt lds
s_waitcnt vmcnt(36)
v_mov_b32 v21, 64
ds_write_b32 v22, v21
s_mov_b32 m0, 12288
s_mov_b32 s76, 622592
buffer_load_dwordx4 v36, s[44:47], s76 offen nt lds
buffer_load_dwordx4 v37, s[44:47], s76 offen offset:1024 nt lds
buffer_load_dwordx4 v38, s[44:47], s76 offen offset:2048 nt lds
buffer_load_dwordx4 v39, s[44:47], s76 offen offset:3072 nt lds
s_waitcnt vmcnt(36)
v_mov_b32 v21, 65
ds_write_b32 v22, v21
s_add_u32 s76, s79, 49152
s_and_b32 s76, s76, 0xffff
s_add_u32 m0, s76, 65536
s_nop 0
buffer_load_dwordx4 v12, s[60:63], s76 offen lds
buffer_load_dwordx4 v13, s[60:63], s76 offen offset:1024 lds
buffer_load_dwordx4 v14, s[60:63], s76 offen offset:2048 lds
buffer_load_dwordx4 v15, s[60:63], s76 offen offset:3072 lds
s_waitcnt vmcnt(36)
v_mov_b32 v21, 66
ds_write_b32 v22, v21
s_add_u32 s76, s79, 53248
s_and_b32 s76, s76, 0xffff
s_add_u32 m0, s76, 65536
s_nop 0
buffer_load_dwordx4 v16, s[60:63], s76 offen lds
buffer_load_dwordx4 v17, s[60:63], s76 offen offset:1024 lds
buffer_load_dwordx4 v18, s[60:63], s76 offen offset:2048 lds
buffer_load_dwordx4 v19, s[60:63], s76 offen offset:3072 lds
s_waitcnt vmcnt(36)
v_mov_b32 v21, 67
ds_write_b32 v22, v21
spin_100:
ds_read_b128 v[24:27], v20 offset:304
s_waitcnt lgkmcnt(0)
v_min_u32 v24, v24, v25
v_min3_u32 v24, v24, v26, v27
s_nop 0
v_readfirstlane_b32 s77, v24
s_nop 0
s_cmp_ge_u32 s77, 3
s_cbranch_scc1 done_101
s_sleep 1
s_add_u32 s39, s39, 1
s_cmp_lt_u32 s39, 262144
s_cbranch_scc1 spin_100
done_101:
s_mov_b32 m0, 16384
s_mov_b32 s76, 655360
buffer_load_dwordx4 v36, s[44:47], s76 offen nt lds
buffer_load_dwordx4 v37, s[44:47], s76 offen offset:1024 nt lds
buffer_load_dwordx4 v38, s[44:47], s76 offen offset:2048 nt lds
buffer_load_dwordx4 v39, s[44:47], s76 offen offset:3072 nt lds
s_waitcnt vmcnt(36)
v_mov_b32 v21, 68
ds_write_b32 v22, v21
s_mov_b32 m0, 20480
s_mov_b32 s76, 688128
buffer_load_dwordx4 v36, s[44:47], s76 offen nt lds
buffer_load_dwordx4 v37, s[44:47], s76 offen offset:1024 nt lds
buffer_load_dwordx4 v38, s[44:47], s76 offen offset:2048 nt lds
buffer_load_dwordx4 v39, s[44:47], s76 offen offset:3072 nt lds
s_waitcnt vmcnt(36)
v_mov_b32 v21, 69
ds_write_b32 v22, v21
s_add_u32 s76, s79, 57344
s_and_b32 s76, s76, 0xffff
s_add_u32 m0, s76, 65536
s_nop 0
buffer_load_dwordx4 v12, s[60:63], s76 offen lds
buffer_load_dwordx4 v13, s[60:63], s76 offen offset:1024 lds
buffer_load_dwordx4 v14, s[60:63], s76 offen offset:2048 lds
buffer_load_dwordx4 v15, s[60:63], s76 offen offset:3072 lds
s_waitcnt vmcnt(36)
v_mov_b32 v21, 70
ds_write_b32 v22, v21
s_add_u32 s76, s79, 61440
s_and_b32 s76, s76, 0xffff
s_add_u32 m0, s76, 65536
s_nop 0
buffer_load_dwordx4 v16, s[60:63], s76 offen lds
buffer_load_dwordx4 v17, s[60:63], s76 offen offset:1024 lds
buffer_load_dwordx4 v18, s[60:63], s76 offen offset:2048 lds
buffer_load_dwordx4 v19, s[60:63], s76 offen offset:3072 lds
s_waitcnt vmcnt(36)
v_mov_b32 v21, 71
ds_write_b32 v22, v21
spin_102:
ds_read_b128 v[24:27], v20 offset:304
s_waitcnt lgkmcnt(0)
v_min_u32 v24, v24, v25
v_min3_u32 v24, v24, v26, v27
s_nop 0
v_readfirstlane_b32 s77, v24
s_nop 0
s_cmp_ge_u32 s77, 4
s_cbranch_scc1 done_103
s_sleep 1
s_add_u32 s39, s39, 1
s_cmp_lt_u32 s39, 262144
s_cbranch_scc1 spin_102
done_103:
s_mov_b32 m0, 24576
s_mov_b32 s76, 720896
buffer_load_dwordx4 v36, s[44:47], s76 offen nt lds
buffer_load_dwordx4 v37, s[44:47], s76 offen offset:1024 nt lds
buffer_load_dwordx4 v38, s[44:47], s76 offen offset:2048 nt lds
buffer_load_dwordx4 v39, s[44:47], s76 offen offset:3072 nt lds
s_waitcnt vmcnt(36)
v_mov_b32 v21, 72
ds_write_b32 v22, v21
s_mov_b32 m0, 28672
s_mov_b32 s76, 753664
buffer_load_dwordx4 v36, s[44:47], s76 offen nt lds
buffer_load_dwordx4 v37, s[44:47], s76 offen offset:1024 nt lds
buffer_load_dwordx4 v38, s[44:47], s76 offen offset:2048 nt lds
buffer_load_dwordx4 v39, s[44:47], s76 offen offset:3072 nt lds
s_waitcnt vmcnt(36)
v_mov_b32 v21, 73
ds_write_b32 v22, v21
spin_104:
ds_read_b128 v[24:27], v20 offset:304
s_waitcnt lgkmcnt(0)
v_min_u32 v24, v24, v25
v_min3_u32 v24, v24, v26, v27
s_nop 0
v_readfirstlane_b32 s77, v24
s_nop 0
s_cmp_ge_u32 s77, 5
s_cbranch_scc1 done_105
s_sleep 1
s_add_u32 s39, s39, 1
s_cmp_lt_u32 s39, 262144
s_cbranch_scc1 spin_104
done_105:
s_mov_b32 m0, 32768
s_mov_b32 s76, 786432
buffer_load_dwordx4 v36, s[44:47], s76 offen nt lds
buffer_load_dwordx4 v37, s[44:47], s76 offen offset:1024 nt lds
buffer_load_dwordx4 v38, s[44:47], s76 offen offset:2048 nt lds
buffer_load_dwordx4 v39, s[44:47], s76 offen offset:3072 nt lds
s_waitcnt vmcnt(36)
v_mov_b32 v21, 74
ds_write_b32 v22, v21
s_mov_b32 m0, 36864
s_mov_b32 s76, 819200
buffer_load_dwordx4 v36, s[44:47], s76 offen nt lds
buffer_load_dwordx4 v37, s[44:47], s76 offen offset:1024 nt lds
buffer_load_dwordx4 v38, s[44:47], s76 offen offset:2048 nt lds
buffer_load_dwordx4 v39, s[44:47], s76 offen offset:3072 nt lds
s_waitcnt vmcnt(36)
v_mov_b32 v21, 75
ds_write_b32 v22, v21
spin_106:
ds_read_b128 v[24:27], v20 offset:304
s_waitcnt lgkmcnt(0)
v_min_u32 v24, v24, v25
v_min3_u32 v24, v24, v26, v27
s_nop 0
v_readfirstlane_b32 s77, v24
s_nop 0
s_cmp_ge_u32 s77, 6
s_cbranch_scc1 done_107
s_sleep 1
s_add_u32 s39, s39, 1
s_cmp_lt_u32 s39, 262144
s_cbranch_scc1 spin_106
done_107:
s_mov_b32 m0, 40960
s_mov_b32 s76, 851968
buffer_load_dwordx4 v36, s[44:47], s76 offen nt lds
buffer_load_dwordx4 v37, s[44:47], s76 offen offset:1024 nt lds
buffer_load_dwordx4 v38, s[44:47], s76 offen offset:2048 nt lds
buffer_load_dwordx4 v39, s[44:47], s76 offen offset:3072 nt lds
s_waitcnt vmcnt(36)
v_mov_b32 v21, 76
ds_write_b32 v22, v21
s_mov_b32 m0, 45056
s_mov_b32 s76, 884736
buffer_load_dwordx4 v36, s[44:47], s76 offen nt lds
buffer_load_dwordx4 v37, s[44:47], s76 offen offset:1024 nt lds
buffer_load_dwordx4 v38, s[44:47], s76 offen offset:2048 nt lds
buffer_load_dwordx4 v39, s[44:47], s76 offen offset:3072 nt lds
s_waitcnt vmcnt(36)
v_mov_b32 v21, 77
ds_write_b32 v22, v21
spin_108:
ds_read_b128 v[24:27], v20 offset:304
s_waitcnt lgkmcnt(0)
v_min_u32 v24, v24, v25
v_min3_u32 v24, v24, v26, v27
s_nop 0
v_readfirstlane_b32 s77, v24
s_nop 0
s_cmp_ge_u32 s77, 7
s_cbranch_scc1 done_109
s_sleep 1
s_add_u32 s39, s39, 1
s_cmp_lt_u32 s39, 262144
s_cbranch_scc1 spin_108
done_109:
s_mov_b32 m0, 49152
s_mov_b32 s76, 917504
buffer_load_dwordx4 v36, s[44:47], s76 offen nt lds
buffer_load_dwordx4 v37, s[44:47], s76 offen offset:1024 nt lds
buffer_load_dwordx4 v38, s[44:47], s76 offen offset:2048 nt lds
buffer_load_dwordx4 v39, s[44:47], s76 offen offset:3072 nt lds
s_waitcnt vmcnt(36)
v_mov_b32 v21, 78
ds_write_b32 v22, v21
s_mov_b32 m0, 53248
s_mov_b32 s76, 950272
buffer_load_dwordx4 v36, s[44:47], s76 offen nt lds
buffer_load_dwordx4 v37, s[44:47], s76 offen offset:1024 nt lds
buffer_load_dwordx4 v38, s[44:47], s76 offen offset:2048 nt lds
buffer_load_dwordx4 v39, s[44:47], s76 offen offset:3072 nt lds
s_waitcnt vmcnt(36)
v_mov_b32 v21, 79
ds_write_b32 v22, v21
spin_110:
ds_read_b128 v[24:27], v20 offset:304
s_waitcnt lgkmcnt(0)
v_min_u32 v24, v24, v25
v_min3_u32 v24, v24, v26, v27
s_nop 0
v_readfirstlane_b32 s77, v24
s_nop 0
s_cmp_ge_u32 s77, 8
s_cbranch_scc1 done_111
s_sleep 1
s_add_u32 s39, s39, 1
s_cmp_lt_u32 s39, 262144
s_cbranch_scc1 spin_110
done_111:
s_mov_b32 m0, 57344
s_mov_b32 s76, 983040
buffer_load_dwordx4 v36, s[44:47], s76 offen nt lds
buffer_load_dwordx4 v37, s[44:47], s76 offen offset:1024 nt lds
buffer_load_dwordx4 v38, s[44:47], s76 offen offset:2048 nt lds
buffer_load_dwordx4 v39, s[44:47], s76 offen offset:3072 nt lds
s_waitcnt vmcnt(36)
v_mov_b32 v21, 80
ds_write_b32 v22, v21
s_mov_b32 m0, 61440
s_mov_b32 s76, 1015808
buffer_load_dwordx4 v36, s[44:47], s76 offen nt lds
buffer_load_dwordx4 v37, s[44:47], s76 offen offset:1024 nt lds
buffer_load_dwordx4 v38, s[44:47], s76 offen offset:2048 nt lds
buffer_load_dwordx4 v39, s[44:47], s76 offen offset:3072 nt lds
s_waitcnt vmcnt(36)
v_mov_b32 v21, 81
ds_write_b32 v22, v21
s_waitcnt vmcnt(32)
v_mov_b32 v21, 82
ds_write_b32 v22, v21
s_waitcnt vmcnt(28)
v_mov_b32 v21, 83
ds_write_b32 v22, v21
s_waitcnt vmcnt(24)
v_mov_b32 v21, 84
ds_write_b32 v22, v21
s_waitcnt vmcnt(20)
v_mov_b32 v21, 85
ds_write_b32 v22, v21
s_waitcnt vmcnt(16)
v_mov_b32 v21, 86
ds_write_b32 v22, v21
s_waitcnt vmcnt(12)
v_mov_b32 v21, 87
ds_write_b32 v22, v21
s_waitcnt vmcnt(8)
v_mov_b32 v21, 88
ds_write_b32 v22, v21
s_waitcnt vmcnt(4)
v_mov_b32 v21, 89
ds_write_b32 v22, v21
s_waitcnt vmcnt(0)
v_mov_b32 v21, 90
ds_write_b32 v22, v21
s_waitcnt lgkmcnt(0)
s_endpgm
L_service:
s_nop 7
s_nop 3
v_lshlrev_b32 v8, 2, v0
v_add_u32 v8, 159488, v8
v_mov_b32 v9, 0
ds_write_b32 v8, v9
ds_write_b32 v8, v9 offset:256
v_mov_b32 v2, 159488
v_mov_b32 v3, 1
s_waitcnt lgkmcnt(0)
s_barrier
s_load_dword s71, s[30:31], 0
v_and_b32 v10, 15, v0
v_lshrrev_b32 v11, 4, v0
v_and_b32 v12, 3, v0
s_lshr_b32 s72, s70, 4
s_lshl_b32 s72, s72, 7
s_and_b32 s73, s70, 15
s_lshl_b32 s73, s73, 2
s_add_u32 s72, s72, s73
v_lshrrev_b32 v15, 5, v0
v_lshlrev_b32 v15, 6, v15
v_add_u32 v15, v15, v12
v_add_u32 v13, s72, v15
s_lshl_b32 s72, s34, 9
v_add_u32 v15, s72, v13
v_lshlrev_b32 v16, 1, v15
global_load_ushort v14, v16, s[8:9]
v_mov_b32 v17, 2097152
v_mov_b32 v18, 4190208
global_load_dword v19, v17, s[30:31] sc1
global_load_dword v19, v18, s[30:31] sc1
v_lshrrev_b32 v60, 2, v0
v_bfe_u32 v61, v0, 3, 2
v_lshlrev_b32 v60, 7, v60
v_and_b32 v62, 3, v0
v_lshl_add_u32 v60, v62, 3, v60
v_add_u32 v60, 131072, v60
v_xor_b32 v62, 0, v61
v_lshl_add_u32 v20, v62, 5, v60
v_xor_b32 v62, 1, v61
v_lshl_add_u32 v21, v62, 5, v60
v_xor_b32 v62, 2, v61
v_lshl_add_u32 v22, v62, 5, v60
v_xor_b32 v62, 3, v61
v_lshl_add_u32 v23, v62, 5, v60
v_lshrrev_b32 v60, 2, v0
v_bfe_u32 v61, v0, 3, 2
v_lshlrev_b32 v60, 7, v60
v_and_b32 v62, 3, v0
v_lshl_add_u32 v60, v62, 3, v60
v_add_u32 v60, 114688, v60
v_xor_b32 v62, 0, v61
v_lshl_add_u32 v24, v62, 5, v60
v_xor_b32 v62, 1, v61
v_lshl_add_u32 v25, v62, 5, v60
v_xor_b32 v62, 2, v61
v_lshl_add_u32 v26, v62, 5, v60
v_xor_b32 v62, 3, v61
v_lshl_add_u32 v27, v62, 5, v60
v_mul_u32_u24 v60, 1040, v12
v_lshl_add_u32 v60, v11, 3, v60
v_add_u32 v60, 147456, v60
s_lshr_b32 s72, s33, 3
s_lshl_b32 s72, s72, 8
v_add_u32 v28, s72, v60
s_mul_i32 s64, s32, 28
s_add_u32 s64, s64, s33
s_and_b32 s72, s64, 3
s_lshl_b32 s72, s72, 8
v_add_u32 v29, s72, v60
v_mul_u32_u24 v31, 144, v12
v_lshl_add_u32 v31, v11, 3, v31
v_add_u32 v31, 152960, v31
v_lshrrev_b32 v17, 2, v10
s_waitcnt lgkmcnt(0)
s_mul_i32 s36, s71, 0x9E3779B1
s_add_u32 s36, s36, 0x7F4A7C15
s_mul_i32 s37, s71, 0x85EBCA6B
s_lshr_b32 s37, s37, 28
s_waitcnt vmcnt(0)
v_mov_b32 v18, s36
v_mov_b32 v19, s37
s_mov_b32 s78, 0
s_lshl_b32 s72, s32, 14
s_bfe_u32 s73, s33, 0x20001
s_lshl_b32 s73, s73, 12
s_add_u32 s72, s72, s73
s_lshr_b32 s73, s33, 3
s_lshl_b32 s73, s73, 10
s_add_u32 s72, s72, s73
s_and_b32 s73, s33, 1
s_lshl_b32 s73, s73, 9
s_add_u32 s72, s72, s73
s_add_u32 s72, s72, 524288
v_lshlrev_b32 v30, 17, v12
v_lshl_add_u32 v30, v17, 6, v30
v_lshl_add_u32 v30, v11, 4, v30
v_add_u32 v30, s72, v30
spin_112:
ds_read_b32 v4, v2 offset:256
s_waitcnt lgkmcnt(0)
v_readfirstlane_b32 s77, v4
s_nop 0
s_cmp_ge_u32 s77, 4
s_cbranch_scc1 done_113
s_sleep 1
s_add_u32 s39, s39, 1
s_cmp_lt_u32 s39, 262144
s_cbranch_scc1 spin_112
done_113:
s_cmp_ge_u32 s78, 4
s_cbranch_scc1 have_114
spin_115:
ds_read_b32 v4, v2 offset:0
s_waitcnt lgkmcnt(0)
v_readfirstlane_b32 s78, v4
s_nop 0
s_cmp_ge_u32 s78, 4
s_cbranch_scc1 done_116
s_sleep 1
s_add_u32 s39, s39, 1
s_cmp_lt_u32 s39, 262144
s_cbranch_scc1 spin_115
done_116:
have_114:
ds_read2_b64 v[64:67], v28 offset0:0 offset1:4
ds_read_b64_tr_b16 v[48:49], v20 offset:0
ds_read_b64_tr_b16 v[50:51], v20 offset:2048
ds_read_b64_tr_b16 v[52:53], v21 offset:0
ds_read_b64_tr_b16 v[54:55], v21 offset:2048
ds_read_b64_tr_b16 v[56:57], v22 offset:0
ds_read_b64_tr_b16 v[58:59], v22 offset:2048
ds_read_b64_tr_b16 v[60:61], v23 offset:0
ds_read_b64_tr_b16 v[62:63], v23 offset:2048
s_waitcnt lgkmcnt(0)
ds_read2_b64 v[84:87], v28 offset0:8 offset1:12
ds_read_b64_tr_b16 v[68:69], v20 offset:4096
ds_read_b64_tr_b16 v[70:71], v20 offset:6144
ds_read_b64_tr_b16 v[72:73], v21 offset:4096
ds_read_b64_tr_b16 v[74:75], v21 offset:6144
ds_read_b64_tr_b16 v[76:77], v22 offset:4096
ds_read_b64_tr_b16 v[78:79], v22 offset:6144
ds_read_b64_tr_b16 v[80:81], v23 offset:4096
ds_read_b64_tr_b16 v[82:83], v23 offset:6144
v_mfma_f32_16x16x32_bf16 v[32:35], v[48:51], v[64:67], 0
v_mfma_f32_16x16x32_bf16 v[36:39], v[52:55], v[64:67], 0
v_mfma_f32_16x16x32_bf16 v[40:43], v[56:59], v[64:67], 0
v_mfma_f32_16x16x32_bf16 v[44:47], v[60:63], v[64:67], 0
s_waitcnt lgkmcnt(0)
ds_read2_b64 v[64:67], v28 offset0:16 offset1:20
ds_read_b64_tr_b16 v[48:49], v20 offset:8192
ds_read_b64_tr_b16 v[50:51], v20 offset:10240
ds_read_b64_tr_b16 v[52:53], v21 offset:8192
ds_read_b64_tr_b16 v[54:55], v21 offset:10240
ds_read_b64_tr_b16 v[56:57], v22 offset:8192
ds_read_b64_tr_b16 v[58:59], v22 offset:10240
ds_read_b64_tr_b16 v[60:61], v23 offset:8192
ds_read_b64_tr_b16 v[62:63], v23 offset:10240
v_mfma_f32_16x16x32_bf16 v[32:35], v[68:71], v[84:87], v[32:35]
v_mfma_f32_16x16x32_bf16 v[36:39], v[72:75], v[84:87], v[36:39]
v_mfma_f32_16x16x32_bf16 v[40:43], v[76:79], v[84:87], v[40:43]
v_mfma_f32_16x16x32_bf16 v[44:47], v[80:83], v[84:87], v[44:47]
s_waitcnt lgkmcnt(0)
ds_read2_b64 v[84:87], v28 offset0:24 offset1:28
ds_read_b64_tr_b16 v[68:69], v20 offset:12288
ds_read_b64_tr_b16 v[70:71], v20 offset:14336
ds_read_b64_tr_b16 v[72:73], v21 offset:12288
ds_read_b64_tr_b16 v[74:75], v21 offset:14336
ds_read_b64_tr_b16 v[76:77], v22 offset:12288
ds_read_b64_tr_b16 v[78:79], v22 offset:14336
ds_read_b64_tr_b16 v[80:81], v23 offset:12288
ds_read_b64_tr_b16 v[82:83], v23 offset:14336
v_mfma_f32_16x16x32_bf16 v[32:35], v[48:51], v[64:67], v[32:35]
v_mfma_f32_16x16x32_bf16 v[36:39], v[52:55], v[64:67], v[36:39]
v_mfma_f32_16x16x32_bf16 v[40:43], v[56:59], v[64:67], v[40:43]
v_mfma_f32_16x16x32_bf16 v[44:47], v[60:63], v[64:67], v[44:47]
s_waitcnt lgkmcnt(0)
v_mfma_f32_16x16x32_bf16 v[32:35], v[68:71], v[84:87], v[32:35]
v_mfma_f32_16x16x32_bf16 v[36:39], v[72:75], v[84:87], v[36:39]
v_mfma_f32_16x16x32_bf16 v[40:43], v[76:79], v[84:87], v[40:43]
v_mfma_f32_16x16x32_bf16 v[44:47], v[80:83], v[84:87], v[44:47]
s_nop 5
v_mov_b32_dpp v32, v36 quad_perm:[0,1,2,3] row_mask:0xf bank_mask:0x2
v_mov_b32_dpp v33, v37 quad_perm:[0,1,2,3] row_mask:0xf bank_mask:0x2
v_mov_b32_dpp v34, v38 quad_perm:[0,1,2,3] row_mask:0xf bank_mask:0x2
v_mov_b32_dpp v35, v39 quad_perm:[0,1,2,3] row_mask:0xf bank_mask:0x2
v_mov_b32_dpp v32, v40 quad_perm:[0,1,2,3] row_mask:0xf bank_mask:0x4
v_mov_b32_dpp v33, v41 quad_perm:[0,1,2,3] row_mask:0xf bank_mask:0x4
v_mov_b32_dpp v34, v42 quad_perm:[0,1,2,3] row_mask:0xf bank_mask:0x4
v_mov_b32_dpp v35, v43 quad_perm:[0,1,2,3] row_mask:0xf bank_mask:0x4
v_mov_b32_dpp v32, v44 quad_perm:[0,1,2,3] row_mask:0xf bank_mask:0x8
v_mov_b32_dpp v33, v45 quad_perm:[0,1,2,3] row_mask:0xf bank_mask:0x8
v_mov_b32_dpp v34, v46 quad_perm:[0,1,2,3] row_mask:0xf bank_mask:0x8
v_mov_b32_dpp v35, v47 quad_perm:[0,1,2,3] row_mask:0xf bank_mask:0x8
v_mov_b32 v4, 1
ds_write_b32 v2, v4 offset:260
v_and_or_b32 v88, v32, s68, v19
v_mov_b32 v89, v18
v_and_or_b32 v90, v33, s68, v19
v_mov_b32 v91, v18
v_and_or_b32 v92, v34, s68, v19
v_mov_b32 v93, v18
v_and_or_b32 v94, v35, s68, v19
v_mov_b32 v95, v18
global_store_dwordx4 v30, v[88:91], s[30:31] sc1
global_store_dwordx4 v30, v[92:95], s[30:31] offset:256 sc1
s_lshr_b32 s72, s64, 3
s_lshl_b32 s72, s72, 14
s_and_b32 s73, s64, 7
s_and_b32 s74, s73, 3
s_lshr_b32 s73, s73, 2
s_lshl_b32 s73, s73, 2
s_add_u32 s73, s73, s74
s_lshl_b32 s73, s73, 8
s_add_u32 s72, s72, s73
s_add_u32 s72, s72, 1048576
v_lshlrev_b32 v30, 5, v12
v_lshl_add_u32 v30, v17, 12, v30
v_lshrrev_b32 v60, 1, v11
v_lshl_add_u32 v30, v60, 11, v30
v_and_b32 v60, 1, v11
v_lshl_add_u32 v30, v60, 4, v30
v_add_u32 v30, s72, v30
s_cmp_ge_u32 s78, 8
s_cbranch_scc1 have_117
spin_118:
ds_read_b32 v4, v2 offset:0
s_waitcnt lgkmcnt(0)
v_readfirstlane_b32 s78, v4
s_nop 0
s_cmp_ge_u32 s78, 8
s_cbranch_scc1 done_119
s_sleep 1
s_add_u32 s39, s39, 1
s_cmp_lt_u32 s39, 262144
s_cbranch_scc1 spin_118
done_119:
have_117:
ds_read2_b64 v[64:67], v29 offset0:0 offset1:4
ds_read_b64_tr_b16 v[48:49], v24 offset:0
ds_read_b64_tr_b16 v[50:51], v24 offset:2048
ds_read_b64_tr_b16 v[52:53], v25 offset:0
ds_read_b64_tr_b16 v[54:55], v25 offset:2048
ds_read_b64_tr_b16 v[56:57], v26 offset:0
ds_read_b64_tr_b16 v[58:59], v26 offset:2048
ds_read_b64_tr_b16 v[60:61], v27 offset:0
ds_read_b64_tr_b16 v[62:63], v27 offset:2048
s_waitcnt lgkmcnt(0)
ds_read2_b64 v[84:87], v29 offset0:8 offset1:12
ds_read_b64_tr_b16 v[68:69], v24 offset:4096
ds_read_b64_tr_b16 v[70:71], v24 offset:6144
ds_read_b64_tr_b16 v[72:73], v25 offset:4096
ds_read_b64_tr_b16 v[74:75], v25 offset:6144
ds_read_b64_tr_b16 v[76:77], v26 offset:4096
ds_read_b64_tr_b16 v[78:79], v26 offset:6144
ds_read_b64_tr_b16 v[80:81], v27 offset:4096
ds_read_b64_tr_b16 v[82:83], v27 offset:6144
v_mfma_f32_16x16x32_bf16 v[32:35], v[48:51], v[64:67], 0
v_mfma_f32_16x16x32_bf16 v[36:39], v[52:55], v[64:67], 0
v_mfma_f32_16x16x32_bf16 v[40:43], v[56:59], v[64:67], 0
v_mfma_f32_16x16x32_bf16 v[44:47], v[60:63], v[64:67], 0
s_waitcnt lgkmcnt(0)
ds_read2_b64 v[64:67], v29 offset0:16 offset1:20
ds_read_b64_tr_b16 v[48:49], v24 offset:8192
ds_read_b64_tr_b16 v[50:51], v24 offset:10240
ds_read_b64_tr_b16 v[52:53], v25 offset:8192
ds_read_b64_tr_b16 v[54:55], v25 offset:10240
ds_read_b64_tr_b16 v[56:57], v26 offset:8192
ds_read_b64_tr_b16 v[58:59], v26 offset:10240
ds_read_b64_tr_b16 v[60:61], v27 offset:8192
ds_read_b64_tr_b16 v[62:63], v27 offset:10240
v_mfma_f32_16x16x32_bf16 v[32:35], v[68:71], v[84:87], v[32:35]
v_mfma_f32_16x16x32_bf16 v[36:39], v[72:75], v[84:87], v[36:39]
v_mfma_f32_16x16x32_bf16 v[40:43], v[76:79], v[84:87], v[40:43]
v_mfma_f32_16x16x32_bf16 v[44:47], v[80:83], v[84:87], v[44:47]
s_waitcnt lgkmcnt(0)
ds_read2_b64 v[84:87], v29 offset0:24 offset1:28
ds_read_b64_tr_b16 v[68:69], v24 offset:12288
ds_read_b64_tr_b16 v[70:71], v24 offset:14336
ds_read_b64_tr_b16 v[72:73], v25 offset:12288
ds_read_b64_tr_b16 v[74:75], v25 offset:14336
ds_read_b64_tr_b16 v[76:77], v26 offset:12288
ds_read_b64_tr_b16 v[78:79], v26 offset:14336
ds_read_b64_tr_b16 v[80:81], v27 offset:12288
ds_read_b64_tr_b16 v[82:83], v27 offset:14336
v_mfma_f32_16x16x32_bf16 v[32:35], v[48:51], v[64:67], v[32:35]
v_mfma_f32_16x16x32_bf16 v[36:39], v[52:55], v[64:67], v[36:39]
v_mfma_f32_16x16x32_bf16 v[40:43], v[56:59], v[64:67], v[40:43]
v_mfma_f32_16x16x32_bf16 v[44:47], v[60:63], v[64:67], v[44:47]
s_waitcnt lgkmcnt(0)
v_mfma_f32_16x16x32_bf16 v[32:35], v[68:71], v[84:87], v[32:35]
v_mfma_f32_16x16x32_bf16 v[36:39], v[72:75], v[84:87], v[36:39]
v_mfma_f32_16x16x32_bf16 v[40:43], v[76:79], v[84:87], v[40:43]
v_mfma_f32_16x16x32_bf16 v[44:47], v[80:83], v[84:87], v[44:47]
s_nop 5
v_mov_b32_dpp v32, v36 quad_perm:[0,1,2,3] row_mask:0xf bank_mask:0x2
v_mov_b32_dpp v33, v37 quad_perm:[0,1,2,3] row_mask:0xf bank_mask:0x2
v_mov_b32_dpp v34, v38 quad_perm:[0,1,2,3] row_mask:0xf bank_mask:0x2
v_mov_b32_dpp v35, v39 quad_perm:[0,1,2,3] row_mask:0xf bank_mask:0x2
v_mov_b32_dpp v32, v40 quad_perm:[0,1,2,3] row_mask:0xf bank_mask:0x4
v_mov_b32_dpp v33, v41 quad_perm:[0,1,2,3] row_mask:0xf bank_mask:0x4
v_mov_b32_dpp v34, v42 quad_perm:[0,1,2,3] row_mask:0xf bank_mask:0x4
v_mov_b32_dpp v35, v43 quad_perm:[0,1,2,3] row_mask:0xf bank_mask:0x4
v_mov_b32_dpp v32, v44 quad_perm:[0,1,2,3] row_mask:0xf bank_mask:0x8
v_mov_b32_dpp v33, v45 quad_perm:[0,1,2,3] row_mask:0xf bank_mask:0x8
v_mov_b32_dpp v34, v46 quad_perm:[0,1,2,3] row_mask:0xf bank_mask:0x8
v_mov_b32_dpp v35, v47 quad_perm:[0,1,2,3] row_mask:0xf bank_mask:0x8
v_mov_b32 v4, 1
ds_write_b32 v2, v4 offset:264
s_cmp_ge_u32 s33, 28
s_cbranch_scc1 noffn_120
v_and_or_b32 v88, v32, s68, v19
v_mov_b32 v89, v18
v_and_or_b32 v90, v33, s68, v19
v_mov_b32 v91, v18
v_and_or_b32 v92, v34, s68, v19
v_mov_b32 v93, v18
v_and_or_b32 v94, v35, s68, v19
v_mov_b32 v95, v18
global_store_dwordx4 v30, v[88:91], s[30:31] sc1
global_store_dwordx4 v30, v[92:95], s[30:31] offset:128 sc1
s_cmp_ge_u32 s78, 22
s_cbranch_scc1 have_121
spin_122:
ds_read_b32 v4, v2 offset:0
s_waitcnt lgkmcnt(0)
v_readfirstlane_b32 s78, v4
s_nop 0
s_cmp_ge_u32 s78, 22
s_cbranch_scc1 done_123
s_sleep 1
s_add_u32 s39, s39, 1
s_cmp_lt_u32 s39, 262144
s_cbranch_scc1 spin_122
done_123:
have_121:
s_lshl_b32 s72, s64, 11
s_add_u32 s72, s72, 1048576
v_lshlrev_b32 v30, 4, v0
v_add_u32 v30, s72, v30
poll_124:
global_load_dwordx4 v[40:43], v30, s[30:31] sc1
global_load_dwordx4 v[44:47], v30, s[30:31] offset:1024 sc1
s_waitcnt vmcnt(0)
v_bitop3_b32 v50, v40, v42, s37 bitop3:0x7e
v_bitop3_b32 v48, v41, v43, s36 bitop3:0x7e
v_and_or_b32 v48, v50, 15, v48
v_bitop3_b32 v50, v44, v46, s37 bitop3:0x7e
v_bitop3_b32 v49, v45, v47, s36 bitop3:0x7e
v_and_or_b32 v49, v50, 15, v49
v_or_b32 v48, v48, v49
v_cmp_ne_u32 vcc, 0, v48
s_nop 0
s_cmp_eq_u64 vcc, 0
s_cbranch_scc1 pdone_125
s_sleep 8
s_add_u32 s39, s39, 1
s_cmp_lt_u32 s39, 262144
s_cbranch_scc1 poll_124
pdone_125:
v_and_b32 v40, s68, v40
v_and_b32 v42, s68, v42
v_and_b32 v44, s68, v44
v_and_b32 v46, s68, v46
s_nop 0
v_permlane32_swap_b32 v40, v44
v_permlane32_swap_b32 v42, v46
v_add_f32 v40, v40, v44
v_add_f32 v42, v42, v46
v_mov_b32 v41, v40
s_nop 1
v_permlane16_swap_b32 v40, v41
v_add_f32 v40, v40, v41
v_mov_b32 v43, v42
s_nop 1
v_permlane16_swap_b32 v42, v43
v_add_f32 v42, v42, v43
v_cvt_pk_bf16_f32 v48, v40, v42
v_lshlrev_b32 v40, 16, v48
v_and_b32 v42, 0xffff0000, v48
s_nop 0
v_permlane32_swap_b32 v40, v44
v_permlane32_swap_b32 v42, v46
v_mul_f32 v41, 0xbfb8aa3b, v40
v_mul_f32 v43, 0xbfb8aa3b, v42
v_exp_f32 v41, v41
v_exp_f32 v43, v43
v_add_f32 v41, 1.0, v41
v_add_f32 v43, 1.0, v43
v_rcp_f32 v41, v41
v_rcp_f32 v43, v43
v_mul_f32 v40, v40, v41
v_mul_f32 v42, v42, v43
v_cvt_pk_bf16_f32 v48, v40, v42
v_lshlrev_b32 v40, 16, v48
v_and_b32 v42, 0xffff0000, v48
v_mul_f32 v40, v40, v44
v_mul_f32 v42, v42, v46
v_cvt_pk_bf16_f32 v40, v40, v42
v_mov_b32 v41, v18
s_lshl_b32 s72, s64, 7
s_add_u32 s72, s72, 65536
v_bfe_u32 v60, v0, 1, 2
v_lshlrev_b32 v30, 5, v60
v_and_b32 v60, 1, v0
v_lshl_add_u32 v30, v60, 4, v30
v_bfe_u32 v60, v0, 3, 1
v_lshl_add_u32 v30, v60, 3, v30
v_add_u32 v30, s72, v30
s_mov_b64 exec, 0xffff
global_store_dwordx2 v30, v[40:41], s[30:31] sc1
s_mov_b64 exec, -1
noffn_120:
s_cmp_ge_u32 s78, 40
s_cbranch_scc1 have_126
spin_127:
ds_read_b32 v4, v2 offset:0
s_waitcnt lgkmcnt(0)
v_readfirstlane_b32 s78, v4
s_nop 0
s_cmp_ge_u32 s78, 40
s_cbranch_scc1 done_128
s_sleep 1
s_add_u32 s39, s39, 1
s_cmp_lt_u32 s39, 262144
s_cbranch_scc1 spin_127
done_128:
have_126:
s_mul_i32 s72, s33, 896
s_add_u32 s72, s72, 65536
v_lshlrev_b32 v30, 4, v0
v_add_u32 v30, s72, v30
v_mov_b32 v40, 0
v_mov_b32 v42, 0
s_mov_b32 exec_hi, 0x00ffffff
poll_129:
global_load_dwordx4 v[40:43], v30, s[30:31] sc1
s_waitcnt vmcnt(0)
v_bitop3_b32 v48, v41, v43, s36 bitop3:0x7e
v_cmp_ne_u32 vcc, 0, v48
s_nop 0
s_cmp_eq_u64 vcc, 0
s_cbranch_scc1 pdone_130
s_sleep 8
s_add_u32 s39, s39, 1
s_cmp_lt_u32 s39, 262144
s_cbranch_scc1 poll_129
pdone_130:
s_mov_b64 exec, -1
v_bfe_u32 v60, v0, 1, 2
v_mul_u32_u24 v60, 144, v60
v_lshrrev_b32 v61, 3, v0
v_lshl_add_u32 v60, v61, 4, v60
v_and_b32 v61, 1, v0
v_lshl_add_u32 v60, v61, 3, v60
v_add_u32 v60, 152960, v60
ds_write2_b32 v60, v40, v42 offset0:0 offset1:1
s_cmp_ge_u32 s78, 18
s_cbranch_scc1 have_131
spin_132:
ds_read_b32 v4, v2 offset:0
s_waitcnt lgkmcnt(0)
v_readfirstlane_b32 s78, v4
s_nop 0
s_cmp_ge_u32 s78, 18
s_cbranch_scc1 done_133
s_sleep 1
s_add_u32 s39, s39, 1
s_cmp_lt_u32 s39, 262144
s_cbranch_scc1 spin_132
done_133:
have_131:
ds_read2_b64 v[64:67], v31 offset0:0 offset1:4
ds_read_b64_tr_b16 v[48:49], v20 offset:0
ds_read_b64_tr_b16 v[50:51], v20 offset:2048
ds_read_b64_tr_b16 v[52:53], v21 offset:0
ds_read_b64_tr_b16 v[54:55], v21 offset:2048
ds_read_b64_tr_b16 v[56:57], v22 offset:0
ds_read_b64_tr_b16 v[58:59], v22 offset:2048
ds_read_b64_tr_b16 v[60:61], v23 offset:0
ds_read_b64_tr_b16 v[62:63], v23 offset:2048
s_waitcnt lgkmcnt(0)
ds_read2_b64 v[84:87], v31 offset0:8 offset1:12
ds_read_b64_tr_b16 v[68:69], v20 offset:4096
ds_read_b64_tr_b16 v[70:71], v20 offset:6144
ds_read_b64_tr_b16 v[72:73], v21 offset:4096
ds_read_b64_tr_b16 v[74:75], v21 offset:6144
ds_read_b64_tr_b16 v[76:77], v22 offset:4096
ds_read_b64_tr_b16 v[78:79], v22 offset:6144
ds_read_b64_tr_b16 v[80:81], v23 offset:4096
ds_read_b64_tr_b16 v[82:83], v23 offset:6144
v_mfma_f32_16x16x32_bf16 v[32:35], v[48:51], v[64:67], 0
v_mfma_f32_16x16x32_bf16 v[36:39], v[52:55], v[64:67], 0
v_mfma_f32_16x16x32_bf16 v[40:43], v[56:59], v[64:67], 0
v_mfma_f32_16x16x32_bf16 v[44:47], v[60:63], v[64:67], 0
s_waitcnt lgkmcnt(0)
v_mfma_f32_16x16x32_bf16 v[32:35], v[68:71], v[84:87], v[32:35]
v_mfma_f32_16x16x32_bf16 v[36:39], v[72:75], v[84:87], v[36:39]
v_mfma_f32_16x16x32_bf16 v[40:43], v[76:79], v[84:87], v[40:43]
v_mfma_f32_16x16x32_bf16 v[44:47], v[80:83], v[84:87], v[44:47]
s_nop 5
v_mov_b32_dpp v32, v36 quad_perm:[0,1,2,3] row_mask:0xf bank_mask:0x2
v_mov_b32_dpp v33, v37 quad_perm:[0,1,2,3] row_mask:0xf bank_mask:0x2
v_mov_b32_dpp v34, v38 quad_perm:[0,1,2,3] row_mask:0xf bank_mask:0x2
v_mov_b32_dpp v35, v39 quad_perm:[0,1,2,3] row_mask:0xf bank_mask:0x2
v_mov_b32_dpp v32, v40 quad_perm:[0,1,2,3] row_mask:0xf bank_mask:0x4
v_mov_b32_dpp v33, v41 quad_perm:[0,1,2,3] row_mask:0xf bank_mask:0x4
v_mov_b32_dpp v34, v42 quad_perm:[0,1,2,3] row_mask:0xf bank_mask:0x4
v_mov_b32_dpp v35, v43 quad_perm:[0,1,2,3] row_mask:0xf bank_mask:0x4
v_mov_b32_dpp v32, v44 quad_perm:[0,1,2,3] row_mask:0xf bank_mask:0x8
v_mov_b32_dpp v33, v45 quad_perm:[0,1,2,3] row_mask:0xf bank_mask:0x8
v_mov_b32_dpp v34, v46 quad_perm:[0,1,2,3] row_mask:0xf bank_mask:0x8
v_mov_b32_dpp v35, v47 quad_perm:[0,1,2,3] row_mask:0xf bank_mask:0x8
s_lshl_b32 s72, s33, 14
s_lshl_b32 s73, s32, 11
s_add_u32 s72, s72, s73
s_add_u32 s72, s72, 1572864
v_lshlrev_b32 v30, 9, v12
v_lshl_add_u32 v30, v17, 6, v30
v_lshl_add_u32 v30, v11, 4, v30
v_add_u32 v30, s72, v30
v_and_or_b32 v88, v32, s68, v19
v_mov_b32 v89, v18
v_and_or_b32 v90, v33, s68, v19
v_mov_b32 v91, v18
v_and_or_b32 v92, v34, s68, v19
v_mov_b32 v93, v18
v_and_or_b32 v94, v35, s68, v19
v_mov_b32 v95, v18
global_store_dwordx4 v30, v[88:91], s[30:31] sc1
global_store_dwordx4 v30, v[92:95], s[30:31] offset:256 sc1
spin_134:
ds_read_b32 v4, v2 offset:276
s_waitcnt lgkmcnt(0)
v_readfirstlane_b32 s77, v4
s_nop 0
s_cmp_ge_u32 s77, 4
s_cbranch_scc1 done_135
s_sleep 1
s_add_u32 s39, s39, 1
s_cmp_lt_u32 s39, 262144
s_cbranch_scc1 spin_134
done_135:
v_lshlrev_b32 v28, 2, v12
v_add_u32 v28, 159360, v28
ds_read_b32 v48, v28 offset:0
ds_read_b32 v52, v28 offset:64
ds_read_b32 v49, v28 offset:16
ds_read_b32 v53, v28 offset:80
ds_read_b32 v50, v28 offset:32
ds_read_b32 v54, v28 offset:96
ds_read_b32 v51, v28 offset:48
ds_read_b32 v55, v28 offset:112
s_waitcnt lgkmcnt(0)
v_max_f32 v48, v48, v49
v_max3_f32 v48, v48, v50, v51
v_add_f32 v52, v52, v53
v_add_f32 v54, v54, v55
v_add_f32 v52, v52, v54
s_getreg_b32 s65, hwreg(HW_REG_XCC_ID)
s_and_b32 s65, s65, 15
s_lshl_b32 s72, s65, 4
v_or_b32 v40, s72, v19
v_and_b32 v48, 0xffff0000, v48
v_or_b32 v40, v40, v48
v_mov_b32 v41, v18
v_and_or_b32 v42, v52, s68, v19
v_mov_b32 v43, v18
s_lshl_b32 s72, s34, 3
s_add_u32 s72, s72, s32
s_lshl_b32 s79, s72, 9
s_lshl_b32 s73, s35, 6
s_add_u32 s72, s79, s73
s_add_u32 s72, s72, 131072
v_lshlrev_b32 v28, 4, v12
v_add_u32 v28, s72, v28
s_mov_b64 exec, 0xf
global_store_dwordx4 v28, v[40:43], s[30:31] sc1
s_mov_b64 exec, -1
s_cmp_ge_u32 s78, 74
s_cbranch_scc1 have_136
spin_137:
ds_read_b32 v4, v2 offset:0
s_waitcnt lgkmcnt(0)
v_readfirstlane_b32 s78, v4
s_nop 0
s_cmp_ge_u32 s78, 74
s_cbranch_scc1 done_138
s_sleep 1
s_add_u32 s39, s39, 1
s_cmp_lt_u32 s39, 262144
s_cbranch_scc1 spin_137
done_138:
have_136:
s_lshr_b32 s72, s35, 1
s_lshl_b32 s72, s72, 4
s_add_u32 s72, s72, s79
s_add_u32 s72, s72, 131072
v_lshrrev_b32 v28, 3, v0
v_lshlrev_b32 v28, 6, v28
v_add_u32 v28, s72, v28
poll_139:
global_load_dwordx4 v[40:43], v28, s[30:31] sc1
s_waitcnt vmcnt(0)
v_bitop3_b32 v50, v40, v42, s37 bitop3:0x7e
v_bitop3_b32 v48, v41, v43, s36 bitop3:0x7e
v_and_or_b32 v48, v50, 15, v48
v_cmp_ne_u32 vcc, 0, v48
s_nop 0
s_cmp_eq_u64 vcc, 0
s_cbranch_scc1 pdone_140
s_sleep 8
s_add_u32 s39, s39, 1
s_cmp_lt_u32 s39, 262144
s_cbranch_scc1 poll_139
pdone_140:
v_and_b32 v40, s68, v40
v_and_b32 v42, s68, v42
v_bfe_u32 v44, v40, 4, 4
v_cmp_ne_u32 vcc, s65, v44
s_nop 0
s_cmp_eq_u64 vcc, 0
s_cselect_b32 s65, 2, 1
v_and_b32 v40, 0xffff0000, v40
v_mov_b32 v44, v40
s_nop 1
v_max_f32_dpp v44, v44, v44 row_ror:8 row_mask:0xf bank_mask:0xf
v_mov_b32 v45, v44
s_nop 1
v_permlane16_swap_b32 v44, v45
v_max_f32 v44, v44, v45
v_mov_b32 v45, v44
s_nop 1
v_permlane32_swap_b32 v44, v45
v_max_f32 v44, v44, v45
v_sub_f32 v40, v40, v44
v_mul_f32 v40, 0x3fb8aa3b, v40
v_exp_f32 v40, v40
s_nop 0
v_mul_f32 v44, v40, v42
s_nop 1
v_add_f32_dpp v44, v44, v44 row_ror:8 row_mask:0xf bank_mask:0xf
v_mov_b32 v45, v44
s_nop 1
v_permlane16_swap_b32 v44, v45
v_add_f32 v44, v44, v45
v_mov_b32 v45, v44
s_nop 1
v_permlane32_swap_b32 v44, v45
v_add_f32 v44, v44, v45
v_rcp_f32 v45, v44
s_nop 0
v_mul_f32 v46, v40, v45
v_fma_f32 v47, -v46, v44, v40
v_fma_f32 v46, v47, v45, v46
v_lshlrev_b32 v28, 2, v0
v_add_u32 v28, 159104, v28
ds_write_b32 v28, v46
v_mov_b32 v4, s65
ds_write_b32 v2, v4 offset:280
s_lshl_b32 s72, s34, 6
s_add_u32 s72, s72, s70
s_lshl_b32 s72, s72, 12
s_add_u32 s72, s72, 3145728
v_lshlrev_b32 v28, 4, v0
v_add_u32 v28, s72, v28
s_waitcnt lgkmcnt(0)
s_barrier
v_bfe_u32 v32, v0, 2, 3
v_lshlrev_b32 v32, 14, v32
v_lshrrev_b32 v60, 5, v0
v_lshl_add_u32 v32, v60, 11, v32
v_bfe_u32 v60, v0, 1, 1
v_lshl_add_u32 v32, v60, 8, v32
v_and_b32 v60, 1, v0
v_lshl_add_u32 v32, v60, 3, v32
s_lshr_b32 s72, s70, 4
s_lshl_b32 s72, s72, 12
s_lshl_b32 s73, s34, 9
s_add_u32 s72, s72, s73
s_and_b32 s73, s70, 15
s_lshl_b32 s73, s73, 4
s_add_u32 s72, s72, s73
s_add_u32 s72, s72, 1572864
v_add_u32 v32, s72, v32
v_add_u32 v61, 131072, v32
v_add_u32 v62, 262144, v32
v_add_u32 v63, 393216, v32
poll_141:
global_load_dwordx2 v[40:41], v32, s[30:31] sc1
global_load_dwordx2 v[42:43], v61, s[30:31] sc1
global_load_dwordx2 v[44:45], v62, s[30:31] sc1
global_load_dwordx2 v[46:47], v63, s[30:31] sc1
s_waitcnt vmcnt(0)
v_xor_b32 v50, s37, v40
v_xor_b32 v48, s36, v41
v_and_or_b32 v48, v50, 15, v48
v_xor_b32 v50, s37, v42
v_xor_b32 v49, s36, v43
v_and_or_b32 v49, v50, 15, v49
v_or_b32 v48, v48, v49
v_xor_b32 v50, s37, v44
v_xor_b32 v49, s36, v45
v_and_or_b32 v49, v50, 15, v49
v_or_b32 v48, v48, v49
v_xor_b32 v50, s37, v46
v_xor_b32 v49, s36, v47
v_and_or_b32 v49, v50, 15, v49
v_or_b32 v48, v48, v49
v_cmp_ne_u32 vcc, 0, v48
s_nop 0
s_cmp_eq_u64 vcc, 0
s_cbranch_scc1 pdone_142
s_sleep 8
s_add_u32 s39, s39, 1
s_cmp_lt_u32 s39, 262144
s_cbranch_scc1 poll_141
pdone_142:
v_and_b32 v40, s68, v40
v_and_b32 v42, s68, v42
v_and_b32 v44, s68, v44
v_and_b32 v46, s68, v46
v_add_f32 v40, v40, v42
v_add_f32 v44, v44, v46
v_add_f32 v40, v40, v44
s_nop 1
v_add_f32_dpp v40, v40, v40 row_ror:4 row_mask:0xf bank_mask:0xf
s_nop 1
v_add_f32_dpp v40, v40, v40 row_ror:8 row_mask:0xf bank_mask:0xf
v_mov_b32 v41, v40
s_nop 1
v_permlane16_swap_b32 v40, v41
v_add_f32 v40, v40, v41
v_cvt_pk_bf16_f32 v40, v40, v40
v_lshlrev_b32 v40, 16, v40
v_mul_f32 v41, 0xbfb8aa3b, v40
v_exp_f32 v41, v41
s_nop 0
v_add_f32 v41, 1.0, v41
v_rcp_f32 v41, v41
s_nop 0
v_mul_f32 v30, v40, v41
v_cvt_pk_bf16_f32 v30, v30, v30
v_lshlrev_b32 v30, 16, v30
v_lshlrev_b32 v14, 16, v14
poll_143:
global_load_dwordx4 v[40:43], v28, s[30:31] offset:0 sc1
global_load_dwordx4 v[44:47], v28, s[30:31] offset:1024 sc1
global_load_dwordx4 v[48:51], v28, s[30:31] offset:2048 sc1
global_load_dwordx4 v[52:55], v28, s[30:31] offset:3072 sc1
s_waitcnt vmcnt(0)
v_bitop3_b32 v58, v40, v42, s37 bitop3:0x7e
v_bitop3_b32 v56, v41, v43, s36 bitop3:0x7e
v_and_or_b32 v56, v58, 15, v56
v_bitop3_b32 v58, v44, v46, s37 bitop3:0x7e
v_bitop3_b32 v57, v45, v47, s36 bitop3:0x7e
v_and_or_b32 v57, v58, 15, v57
v_or_b32 v56, v56, v57
v_bitop3_b32 v58, v48, v50, s37 bitop3:0x7e
v_bitop3_b32 v57, v49, v51, s36 bitop3:0x7e
v_and_or_b32 v57, v58, 15, v57
v_or_b32 v56, v56, v57
v_bitop3_b32 v58, v52, v54, s37 bitop3:0x7e
v_bitop3_b32 v57, v53, v55, s36 bitop3:0x7e
v_and_or_b32 v57, v58, 15, v57
v_or_b32 v56, v56, v57
v_cmp_ne_u32 vcc, 0, v56
s_nop 0
s_cmp_eq_u64 vcc, 0
s_cbranch_scc1 pdone_144
s_add_u32 s39, s39, 1
s_cmp_lt_u32 s39, 262144
s_cbranch_scc1 poll_143
pdone_144:
v_and_b32 v40, s68, v40
v_and_b32 v42, s68, v42
v_and_b32 v44, s68, v44
v_and_b32 v46, s68, v46
v_and_b32 v48, s68, v48
v_and_b32 v50, s68, v50
v_and_b32 v52, s68, v52
v_and_b32 v54, s68, v54
v_add_f32 v40, v40, v44
v_add_f32 v42, v42, v46
v_add_f32 v48, v48, v52
v_add_f32 v50, v50, v54
v_add_f32 v40, v40, v48
v_add_f32 v42, v42, v50
s_nop 1
v_permlane32_swap_b32 v40, v42
v_add_f32 v40, v40, v42
v_mov_b32 v41, v40
s_nop 1
v_permlane16_swap_b32 v40, v41
v_add_f32 v40, v40, v41
s_nop 1
v_add_f32_dpp v40, v40, v40 row_ror:8 row_mask:0xf bank_mask:0xf
s_nop 1
v_add_f32_dpp v40, v40, v40 row_ror:4 row_mask:0xf bank_mask:0xf
v_cvt_pk_bf16_f32 v40, v40, v40
v_lshlrev_b32 v40, 16, v40
v_mul_f32 v40, v40, v30
v_cvt_pk_bf16_f32 v40, v40, v40
v_lshlrev_b32 v40, 16, v40
v_add_f32 v40, v40, v14
v_cvt_pk_bf16_f32 v40, v40, v40
s_mov_b32 exec_lo, 0xf
s_mov_b32 exec_hi, 0xf
global_store_short v16, v40, s[26:27]
s_cmp_lg_u32 s2, 0
s_cbranch_scc1 noepoch_145
s_mov_b64 exec, 1
v_mov_b32 v41, 0
global_store_dword v41, v18, s[30:31]
noepoch_145:
s_endpgm
L_code_end:
.section .rodata,"a"
.p2align 6
.amdhsa_kernel recurrent_scan__gqa_block_cached__swiglu_ffn__decode_kernel
  .amdhsa_next_free_vgpr 236
  .amdhsa_next_free_sgpr 102
  .amdhsa_accum_offset 236
  .amdhsa_group_segment_fixed_size 0
  .amdhsa_kernarg_size 96
  .amdhsa_user_sgpr_count 2
  .amdhsa_user_sgpr_kernarg_segment_ptr 1
  .amdhsa_system_sgpr_workgroup_id_x 1
.end_amdhsa_kernel
```
